```python
import torch

def _softmax(x, axis=-1):
    return torch.softmax(x, dim=axis)

def _gelu(x):
    return torch.nn.functional.gelu(x, approximate='tanh')

def _silu(x):
    return torch.nn.functional.silu(x)

def _sigmoid(x):
    return torch.sigmoid(x)

def _layernorm(x, axis=-1, eps=1e-05):
    m = x.mean(dim=axis, keepdim=True)
    v = x.var(dim=axis, keepdim=True, unbiased=False)
    return (x - m) / torch.sqrt(v + eps)

def _scatter_add(tgt, idx, src, axis=0):
    return tgt.clone().index_add_(axis, idx, src)

def _segment_sum(src, seg, n):
    out = torch.zeros((n,) + src.shape[1:], dtype=src.dtype)
    return out.index_add_(0, seg, src)

def _pad(x, pw):
    flat = tuple((v for pair in reversed(pw) for v in pair))
    return torch.nn.functional.pad(x, flat)
kernel_name = 'standalone__tree_speculative_verify_tree_attention_over_candidate_token_tree__sampling'

def setup_inputs():

    _w = lambda a: (lambda t: t.to(torch.bfloat16) if t.is_floating_point() else t)(torch.as_tensor(a))
    B, Hq, Hkv, T, C, D = (8, 16, 8, 16, 8192, 256)
    tree_mask = torch.zeros((B, T, T), dtype=float)
    for b in range(B):
        parent = torch.zeros(T, dtype=torch.int64)
        for i in range(1, T):
            parent[i] = int(torch.randint(0, i, (1,)).item())
        for i in range(T):
            j = i
            tree_mask[b, i, j] = 1.0
            while j > 0:
                j = parent[j]
                tree_mask[b, i, j] = 1.0
    return {'q': _w((lambda *s: torch.randn(*s, dtype=torch.bfloat16) * 0.8)(B, Hq, T, D)), 'k_cache': _w((lambda *s: torch.randn(*s, dtype=torch.bfloat16) * 0.8)(B, Hkv, C, D)), 'v_cache': _w((lambda *s: torch.randn(*s, dtype=torch.bfloat16) * 0.05)(B, Hkv, C, D)), 'k_tree': _w((lambda *s: torch.randn(*s, dtype=torch.bfloat16) * 0.8)(B, Hkv, T, D)), 'v_tree': _w((lambda *s: torch.randn(*s, dtype=torch.bfloat16) * 0.05)(B, Hkv, T, D)), 'tree_mask': _w(tree_mask)}

def reference(q, k_cache, v_cache, k_tree, v_tree, tree_mask):
    B, Hq, T, D = q.shape
    Hkv, C = (k_cache.shape[1], k_cache.shape[2])
    rep = Hq // Hkv
    kc = (lambda x, n, axis: torch.repeat_interleave(x, n, dim=axis))(k_cache, rep, axis=1)
    vc = (lambda x, n, axis: torch.repeat_interleave(x, n, dim=axis))(v_cache, rep, axis=1)
    kt = (lambda x, n, axis: torch.repeat_interleave(x, n, dim=axis))(k_tree, rep, axis=1)
    vt = (lambda x, n, axis: torch.repeat_interleave(x, n, dim=axis))(v_tree, rep, axis=1)
    k = torch.concatenate([kc, kt], axis=2)
    v = torch.concatenate([vc, vt], axis=2)
    scale = D ** (-0.5)
    scores = torch.einsum('bhqd,bhkd->bhqk', q, k) * scale
    ctx_mask = torch.ones((B, 1, T, C), dtype=scores.dtype)
    tm = tree_mask[:, None, :, :].clone()
    full_mask = torch.concatenate([ctx_mask, tm], axis=-1)
    scores = scores + (1.0 - full_mask) * -1000000000.0
    p = _softmax(scores, axis=-1)
    return torch.einsum('bhqk,bhkd->bhqd', p, v)
```

```asm
; @launch grid=(256,1,1) block=(448,1,1) lds=162880
.amdgcn_target "amdgcn-amd-amdhsa--gfx950"
.text
.globl standalone__tree_speculative_verify_tree_attention_over_candidate_token_tree__sampling_kernel
.p2align 8
.type standalone__tree_speculative_verify_tree_attention_over_candidate_token_tree__sampling_kernel,@function
standalone__tree_speculative_verify_tree_attention_over_candidate_token_tree__sampling_kernel:
    s_cmp_ge_u32 s2, 256
    s_cbranch_scc1 L_end
    s_load_dwordx16 s[4:19], s[0:1], 0
    s_load_dwordx2 s[20:21], s[0:1], 64
    v_lshrrev_b32 v2, 6, v0
    v_and_b32 v1, 63, v0
    v_readfirstlane_b32 s22, v2
    v_lshrrev_b32 v3, 5, v1
    v_and_b32 v4, 31, v1
    s_and_b32 s23, s2, 63
    s_lshr_b32 s3, s2, 6
    v_mov_b32 v14, 162304
    v_mov_b32 v13, 0
    s_mov_b32 s71, 400000
    s_cmp_lg_u32 s22, 0
    s_cbranch_scc1 L_notloader
    s_setprio 3
    v_xor_b32 v5, v4, v3
    v_lshlrev_b32 v5, 4, v5
    v_lshl_or_b32 v5, v3, 9, v5
    v_xor_b32 v64, 0, v5
    v_xor_b32 v65, 32, v5
    v_xor_b32 v66, 64, v5
    v_xor_b32 v67, 96, v5
    v_xor_b32 v68, 4224, v5
    v_xor_b32 v69, 4256, v5
    v_xor_b32 v70, 4288, v5
    v_xor_b32 v71, 4320, v5
    v_lshlrev_b32 v6, 2, v3
    v_xor_b32 v6, v4, v6
    v_lshlrev_b32 v6, 4, v6
    v_lshl_or_b32 v6, v3, 9, v6
    v_xor_b32 v72, 0, v6
    v_xor_b32 v73, 128, v6
    v_xor_b32 v74, 4096, v6
    v_xor_b32 v75, 4224, v6
    s_mul_i32 s70, s23, 13
    s_and_b32 s60, s70, 63
    s_lshl_b32 s60, s60, 16
    s_add_u32 s61, s60, 8192
    s_lshl_b32 s72, s23, 22
    s_lshl_b32 s73, s3, 14
    s_add_u32 s72, s72, s73
    s_mov_b32 s65, 0
    s_waitcnt lgkmcnt(0)
    s_add_u32 s24, s6, s72
    s_addc_u32 s25, s7, 0
    s_and_b32 s25, s25, 0xffff
    s_mov_b32 s26, 4145152
    s_mov_b32 s27, 0x00020000
    s_add_u32 m0, s65, 0
    s_nop 0
    buffer_load_dwordx4 v64, s[24:27], s60 offen offset:0 nt lds
    buffer_load_dwordx4 v65, s[24:27], s60 offen offset:1024 nt lds
    buffer_load_dwordx4 v66, s[24:27], s60 offen offset:2048 nt lds
    buffer_load_dwordx4 v67, s[24:27], s60 offen offset:3072 nt lds
    s_add_u32 m0, s65, 4096
    s_nop 0
    buffer_load_dwordx4 v68, s[24:27], s60 offen offset:0 nt lds
    buffer_load_dwordx4 v69, s[24:27], s60 offen offset:1024 nt lds
    buffer_load_dwordx4 v70, s[24:27], s60 offen offset:2048 nt lds
    buffer_load_dwordx4 v71, s[24:27], s60 offen offset:3072 nt lds
    s_add_u32 m0, s65, 8192
    s_nop 0
    buffer_load_dwordx4 v64, s[24:27], s61 offen offset:0 nt lds
    buffer_load_dwordx4 v65, s[24:27], s61 offen offset:1024 nt lds
    buffer_load_dwordx4 v66, s[24:27], s61 offen offset:2048 nt lds
    buffer_load_dwordx4 v67, s[24:27], s61 offen offset:3072 nt lds
    s_add_u32 m0, s65, 12288
    s_nop 0
    buffer_load_dwordx4 v68, s[24:27], s61 offen offset:0 nt lds
    buffer_load_dwordx4 v69, s[24:27], s61 offen offset:1024 nt lds
    buffer_load_dwordx4 v70, s[24:27], s61 offen offset:2048 nt lds
    buffer_load_dwordx4 v71, s[24:27], s61 offen offset:3072 nt lds
    s_add_u32 s28, s8, s72
    s_addc_u32 s29, s9, 0
    s_and_b32 s29, s29, 0xffff
    s_mov_b32 s30, 4145152
    s_mov_b32 s31, 0x00020000
    v_mov_b32 v12, 0
    ds_write_b64 v14, v[12:13]
    ds_write_b64 v14, v[12:13] offset:8
    s_mov_b32 s43, 2
    s_mov_b32 s62, 1
    s_mov_b32 s42, 1
    s_waitcnt lgkmcnt(0)
    s_barrier
L_ld_K:
    s_add_u32 s60, s70, s42
    s_and_b32 s60, s60, 63
    s_lshl_b32 s60, s60, 16
    s_add_u32 s61, s60, 8192
    s_mul_i32 s72, s62, 43691
    s_lshr_b32 s72, s72, 17
    s_mul_i32 s73, s72, 3
    s_sub_u32 s73, s62, s73
    s_lshl_b32 s65, s73, 14
    s_and_b32 s72, s72, 1
    s_cmp_lt_u32 s62, 12
    s_cselect_b32 s72, s72, 0
    s_mul_i32 s72, s72, 81920
    s_add_u32 s65, s65, s72
    s_cmp_lt_u32 s62, 12
    s_cselect_b32 s76, 5, 2
    ds_read_b128 v[48:51], v14 offset:16
    ds_read_b64 v[52:53], v14 offset:32
    s_waitcnt lgkmcnt(0)
    v_min3_u32 v48, v48, v49, v50
    v_min3_u32 v51, v51, v52, v53
    v_min_u32 v48, v48, v51
    s_nop 0
    v_readfirstlane_b32 s72, v48
    s_nop 0
    s_add_u32 s72, s72, s76
    s_waitcnt vmcnt(16)
    s_sub_i32 s74, s43, 2
    s_max_i32 s74, s74, 0
    v_mov_b32 v39, s74
    ds_write_b32 v14, v39
    s_add_u32 s43, s43, 1
L_ld_chkK:
    s_cmp_ge_u32 s72, s62
    s_cbranch_scc1 L_ld_freeK
    s_sub_u32 s71, s71, 1
    s_cbranch_scc1 L_end
    ds_read_b128 v[48:51], v14 offset:16
    ds_read_b64 v[52:53], v14 offset:32
    s_waitcnt lgkmcnt(0)
    v_min3_u32 v48, v48, v49, v50
    v_min3_u32 v51, v51, v52, v53
    v_min_u32 v48, v48, v51
    s_nop 0
    v_readfirstlane_b32 s72, v48
    s_nop 0
    s_add_u32 s72, s72, s76
    s_branch L_ld_chkK
L_ld_freeK:
    s_add_u32 m0, s65, 0
    s_nop 0
    buffer_load_dwordx4 v64, s[24:27], s60 offen offset:0 nt lds
    buffer_load_dwordx4 v65, s[24:27], s60 offen offset:1024 nt lds
    buffer_load_dwordx4 v66, s[24:27], s60 offen offset:2048 nt lds
    buffer_load_dwordx4 v67, s[24:27], s60 offen offset:3072 nt lds
    s_add_u32 m0, s65, 4096
    s_nop 0
    buffer_load_dwordx4 v68, s[24:27], s60 offen offset:0 nt lds
    buffer_load_dwordx4 v69, s[24:27], s60 offen offset:1024 nt lds
    buffer_load_dwordx4 v70, s[24:27], s60 offen offset:2048 nt lds
    buffer_load_dwordx4 v71, s[24:27], s60 offen offset:3072 nt lds
    s_waitcnt vmcnt(16)
    s_sub_i32 s74, s43, 2
    s_max_i32 s74, s74, 0
    v_mov_b32 v39, s74
    ds_write_b32 v14, v39
    s_add_u32 s43, s43, 1
    s_add_u32 m0, s65, 8192
    s_nop 0
    buffer_load_dwordx4 v64, s[24:27], s61 offen offset:0 nt lds
    buffer_load_dwordx4 v65, s[24:27], s61 offen offset:1024 nt lds
    buffer_load_dwordx4 v66, s[24:27], s61 offen offset:2048 nt lds
    buffer_load_dwordx4 v67, s[24:27], s61 offen offset:3072 nt lds
    s_add_u32 m0, s65, 12288
    s_nop 0
    buffer_load_dwordx4 v68, s[24:27], s61 offen offset:0 nt lds
    buffer_load_dwordx4 v69, s[24:27], s61 offen offset:1024 nt lds
    buffer_load_dwordx4 v70, s[24:27], s61 offen offset:2048 nt lds
    buffer_load_dwordx4 v71, s[24:27], s61 offen offset:3072 nt lds
    s_add_u32 s62, s62, 1
    s_add_u32 s42, s42, 1
    s_cmp_lt_u32 s42, 64
    s_cbranch_scc1 L_ld_K
    s_mov_b32 s42, 0
L_ld_V:
    s_add_u32 s60, s70, s42
    s_and_b32 s60, s60, 63
    s_lshl_b32 s60, s60, 16
    s_add_u32 s61, s60, 8192
    s_mul_i32 s72, s62, 43691
    s_lshr_b32 s72, s72, 17
    s_mul_i32 s73, s72, 3
    s_sub_u32 s73, s62, s73
    s_lshl_b32 s65, s73, 14
    s_cmp_lt_u32 s62, 12
    s_cselect_b32 s76, 5, 2
    ds_read_b128 v[48:51], v14 offset:16
    ds_read_b64 v[52:53], v14 offset:32
    s_waitcnt lgkmcnt(0)
    v_min3_u32 v48, v48, v49, v50
    v_min3_u32 v51, v51, v52, v53
    v_min_u32 v48, v48, v51
    s_nop 0
    v_readfirstlane_b32 s72, v48
    s_nop 0
    s_add_u32 s72, s72, s76
    s_waitcnt vmcnt(16)
    s_sub_i32 s74, s43, 2
    s_max_i32 s74, s74, 0
    v_mov_b32 v39, s74
    ds_write_b32 v14, v39
    s_add_u32 s43, s43, 1
L_ld_chkV:
    s_cmp_ge_u32 s72, s62
    s_cbranch_scc1 L_ld_freeV
    s_sub_u32 s71, s71, 1
    s_cbranch_scc1 L_end
    ds_read_b128 v[48:51], v14 offset:16
    ds_read_b64 v[52:53], v14 offset:32
    s_waitcnt lgkmcnt(0)
    v_min3_u32 v48, v48, v49, v50
    v_min3_u32 v51, v51, v52, v53
    v_min_u32 v48, v48, v51
    s_nop 0
    v_readfirstlane_b32 s72, v48
    s_nop 0
    s_add_u32 s72, s72, s76
    s_branch L_ld_chkV
L_ld_freeV:
    s_add_u32 m0, s65, 0
    s_nop 0
    buffer_load_dwordx4 v72, s[28:31], s60 offen offset:0 nt lds
    buffer_load_dwordx4 v73, s[28:31], s60 offen offset:1024 nt lds
    buffer_load_dwordx4 v72, s[28:31], s60 offen offset:2048 nt lds
    buffer_load_dwordx4 v73, s[28:31], s60 offen offset:3072 nt lds
    s_add_u32 m0, s65, 4096
    s_nop 0
    buffer_load_dwordx4 v74, s[28:31], s60 offen offset:0 nt lds
    buffer_load_dwordx4 v75, s[28:31], s60 offen offset:1024 nt lds
    buffer_load_dwordx4 v74, s[28:31], s60 offen offset:2048 nt lds
    buffer_load_dwordx4 v75, s[28:31], s60 offen offset:3072 nt lds
    s_waitcnt vmcnt(16)
    s_sub_i32 s74, s43, 2
    s_max_i32 s74, s74, 0
    v_mov_b32 v39, s74
    ds_write_b32 v14, v39
    s_add_u32 s43, s43, 1
    s_add_u32 m0, s65, 8192
    s_nop 0
    buffer_load_dwordx4 v72, s[28:31], s61 offen offset:0 nt lds
    buffer_load_dwordx4 v73, s[28:31], s61 offen offset:1024 nt lds
    buffer_load_dwordx4 v72, s[28:31], s61 offen offset:2048 nt lds
    buffer_load_dwordx4 v73, s[28:31], s61 offen offset:3072 nt lds
    s_add_u32 m0, s65, 12288
    s_nop 0
    buffer_load_dwordx4 v74, s[28:31], s61 offen offset:0 nt lds
    buffer_load_dwordx4 v75, s[28:31], s61 offen offset:1024 nt lds
    buffer_load_dwordx4 v74, s[28:31], s61 offen offset:2048 nt lds
    buffer_load_dwordx4 v75, s[28:31], s61 offen offset:3072 nt lds
    s_add_u32 s62, s62, 1
    s_add_u32 s42, s42, 1
    s_cmp_lt_u32 s42, 64
    s_cbranch_scc1 L_ld_V
    s_mov_b32 s42, 0
    s_waitcnt vmcnt(16)
    v_mov_b32 v39, 254
    ds_write_b32 v14, v39
    s_waitcnt vmcnt(8)
    v_mov_b32 v39, 255
    ds_write_b32 v14, v39
    s_waitcnt vmcnt(0)
    v_mov_b32 v39, 256
    ds_write_b32 v14, v39
    s_endpgm
L_notloader:
    v_lshlrev_b32 v21, 4, v1
    v_add_u32 v18, 49152, v21
    v_lshlrev_b32 v19, 2, v4
    v_add_u32 v19, 155648, v19
    s_mov_b32 s68, 0
    s_cmp_ge_u32 s22, 3
    s_cbranch_scc1 L_pvwave
    s_sub_u32 s66, s22, 1
    s_lshl_b32 s72, s66, 2
    s_add_u32 s73, s72, 162336
    v_mov_b32 v15, s73
    s_add_u32 s73, s72, 162312
    v_mov_b32 v25, s73
    v_mov_b32 v39, s66
    ds_write_b32 v15, v39
    v_and_b32 v5, 15, v4
    v_xor_b32 v5, v5, v3
    v_lshlrev_b32 v5, 4, v5
    v_lshl_or_b32 v16, v4, 9, v5
    s_mov_b32 s63, 0x3db8aa3b
    s_mov_b32 s64, 0xceabfb8f
    v_mov_b32 v10, 0xff800000
    v_mov_b32 v11, 0
    s_xor_b32 s80, s3, 3
    s_or_b32 s80, s80, s66
    s_waitcnt lgkmcnt(0)
    s_cmp_lg_u32 s80, 0
    s_cbranch_scc1 L_p_nomask
    s_mov_b32 s44, s14
    s_and_b32 s45, s15, 0xffff
    s_mov_b32 s46, 4096
    s_mov_b32 s47, 0x00020000
    v_and_b32 v8, 15, v1
    v_lshlrev_b32 v8, 5, v8
    v_lshl_or_b32 v8, v3, 3, v8
    s_lshr_b32 s76, s23, 3
    s_lshl_b32 s76, s76, 9
    buffer_load_dwordx2 v[64:65], v8, s[44:47], s76 offen
    buffer_load_dwordx2 v[66:67], v8, s[44:47], s76 offen offset:16
L_p_nomask:
    s_barrier
    v_add_u32 v28, 49152, v16
    v_xor_b32 v29, 32, v28
    v_xor_b32 v30, 64, v28
    v_xor_b32 v31, 96, v28
    v_xor_b32 v32, 128, v28
    v_xor_b32 v33, 160, v28
    v_xor_b32 v34, 192, v28
    v_xor_b32 v35, 224, v28
L_poll_1:
    ds_read_b32 v39, v14 offset:4
    s_waitcnt lgkmcnt(0)
    v_readfirstlane_b32 s67, v39
    s_nop 0
    s_cmp_ge_u32 s67, 4
    s_cbranch_scc1 L_go_2
    s_sleep 1
    s_sub_u32 s71, s71, 1
    s_cbranch_scc1 L_end
    s_branch L_poll_1
L_go_2:
    ds_read_b128 v[192:195], v28 offset:0
    ds_read_b128 v[196:199], v29 offset:0
    ds_read_b128 v[200:203], v30 offset:0
    ds_read_b128 v[204:207], v31 offset:0
    ds_read_b128 v[208:211], v32 offset:0
    ds_read_b128 v[212:215], v33 offset:0
    ds_read_b128 v[216:219], v34 offset:0
    ds_read_b128 v[220:223], v35 offset:0
    ds_read_b128 v[224:227], v28 offset:256
    ds_read_b128 v[228:231], v29 offset:256
    ds_read_b128 v[232:235], v30 offset:256
    ds_read_b128 v[236:239], v31 offset:256
    ds_read_b128 v[240:243], v32 offset:256
    ds_read_b128 v[244:247], v33 offset:256
    ds_read_b128 v[248:251], v34 offset:256
    ds_read_b128 v[252:255], v35 offset:256
    s_cmp_lg_u32 s80, 0
    s_cbranch_scc1 L_p_notree
    v_add_u32 v28, 65536, v16
    v_xor_b32 v29, 32, v28
    v_xor_b32 v30, 64, v28
    v_xor_b32 v31, 96, v28
    v_xor_b32 v32, 128, v28
    v_xor_b32 v33, 160, v28
    v_xor_b32 v34, 192, v28
    v_xor_b32 v35, 224, v28
    ds_read_b128 v[128:131], v28 offset:0
    ds_read_b128 v[132:135], v29 offset:0
    ds_read_b128 v[136:139], v30 offset:0
    ds_read_b128 v[140:143], v31 offset:0
    ds_read_b128 v[144:147], v32 offset:0
    ds_read_b128 v[148:151], v33 offset:0
    ds_read_b128 v[152:155], v34 offset:0
    ds_read_b128 v[156:159], v35 offset:0
    ds_read_b128 v[160:163], v28 offset:256
    ds_read_b128 v[164:167], v29 offset:256
    ds_read_b128 v[168:171], v30 offset:256
    ds_read_b128 v[172:175], v31 offset:256
    ds_read_b128 v[176:179], v32 offset:256
    ds_read_b128 v[180:183], v33 offset:256
    ds_read_b128 v[184:187], v34 offset:256
    ds_read_b128 v[188:191], v35 offset:256
    s_waitcnt vmcnt(0)
    v_lshlrev_b32 v68, 16, v64
    v_and_b32 v69, 0xffff0000, v64
    v_lshlrev_b32 v70, 16, v65
    v_and_b32 v71, 0xffff0000, v65
    v_lshlrev_b32 v72, 16, v66
    v_and_b32 v73, 0xffff0000, v66
    v_lshlrev_b32 v74, 16, v67
    v_and_b32 v75, 0xffff0000, v67
    v_sub_f32 v68, 1.0, v68
    v_sub_f32 v69, 1.0, v69
    v_sub_f32 v70, 1.0, v70
    v_sub_f32 v71, 1.0, v71
    v_sub_f32 v72, 1.0, v72
    v_sub_f32 v73, 1.0, v73
    v_sub_f32 v74, 1.0, v74
    v_sub_f32 v75, 1.0, v75
    v_mul_f32 v68, s64, v68
    v_mul_f32 v69, s64, v69
    v_mul_f32 v70, s64, v70
    v_mul_f32 v71, s64, v71
    v_mul_f32 v72, s64, v72
    v_mul_f32 v73, s64, v73
    v_mul_f32 v74, s64, v74
    v_mul_f32 v75, s64, v75
    s_waitcnt lgkmcnt(0)
    v_mfma_f32_32x32x16_bf16 v[48:63], v[128:131], v[192:195], 0
    v_mfma_f32_32x32x16_bf16 v[48:63], v[132:135], v[196:199], v[48:63]
    v_mfma_f32_32x32x16_bf16 v[48:63], v[136:139], v[200:203], v[48:63]
    v_mfma_f32_32x32x16_bf16 v[48:63], v[140:143], v[204:207], v[48:63]
    v_mfma_f32_32x32x16_bf16 v[48:63], v[144:147], v[208:211], v[48:63]
    v_mfma_f32_32x32x16_bf16 v[48:63], v[148:151], v[212:215], v[48:63]
    v_mfma_f32_32x32x16_bf16 v[48:63], v[152:155], v[216:219], v[48:63]
    v_mfma_f32_32x32x16_bf16 v[48:63], v[156:159], v[220:223], v[48:63]
    v_mfma_f32_32x32x16_bf16 v[48:63], v[160:163], v[224:227], v[48:63]
    v_mfma_f32_32x32x16_bf16 v[48:63], v[164:167], v[228:231], v[48:63]
    v_mfma_f32_32x32x16_bf16 v[48:63], v[168:171], v[232:235], v[48:63]
    v_mfma_f32_32x32x16_bf16 v[48:63], v[172:175], v[236:239], v[48:63]
    v_mfma_f32_32x32x16_bf16 v[48:63], v[176:179], v[240:243], v[48:63]
    v_mfma_f32_32x32x16_bf16 v[48:63], v[180:183], v[244:247], v[48:63]
    v_mfma_f32_32x32x16_bf16 v[48:63], v[184:187], v[248:251], v[48:63]
    v_mfma_f32_32x32x16_bf16 v[48:63], v[188:191], v[252:255], v[48:63]
    s_nop 15
    v_fma_f32 v48, v48, s63, v68
    v_fma_f32 v49, v49, s63, v69
    v_fma_f32 v50, v50, s63, v70
    v_fma_f32 v51, v51, s63, v71
    v_fma_f32 v52, v52, s63, v72
    v_fma_f32 v53, v53, s63, v73
    v_fma_f32 v54, v54, s63, v74
    v_fma_f32 v55, v55, s63, v75
    v_max3_f32 v2, v48, v49, v50
    v_max3_f32 v3, v51, v52, v53
    v_max3_f32 v2, v2, v54, v55
    v_max_f32 v2, v2, v3
    v_mov_b32 v3, v2
    s_nop 1
    v_permlane32_swap_b32 v2, v3
    s_nop 1
    v_max_f32 v10, v2, v3
    v_sub_f32 v48, v48, v10
    v_sub_f32 v49, v49, v10
    v_sub_f32 v50, v50, v10
    v_sub_f32 v51, v51, v10
    v_sub_f32 v52, v52, v10
    v_sub_f32 v53, v53, v10
    v_sub_f32 v54, v54, v10
    v_sub_f32 v55, v55, v10
    v_exp_f32 v48, v48
    v_exp_f32 v49, v49
    v_exp_f32 v50, v50
    v_exp_f32 v51, v51
    v_exp_f32 v52, v52
    v_exp_f32 v53, v53
    v_exp_f32 v54, v54
    v_exp_f32 v55, v55
    s_nop 0
    v_add_f32 v11, v48, v49
    v_add_f32 v11, v11, v50
    v_add_f32 v11, v11, v51
    v_add_f32 v11, v11, v52
    v_add_f32 v11, v11, v53
    v_add_f32 v11, v11, v54
    v_add_f32 v11, v11, v55
    v_cvt_pk_bf16_f32 v40, v48, v49
    v_cvt_pk_bf16_f32 v41, v50, v51
    v_cvt_pk_bf16_f32 v42, v52, v53
    v_cvt_pk_bf16_f32 v43, v54, v55
    ds_write_b128 v18, v[40:43] offset:16384
L_p_notree:
    s_mov_b32 s70, 1
    v_mov_b32 v38, 1
    s_waitcnt lgkmcnt(0)
    ds_write_b32 v25, v38
    s_mov_b32 s42, s66
.p2align 6
L_kloop:
    s_mov_b32 s62, s42
    s_mul_i32 s72, s62, 43691
    s_lshr_b32 s72, s72, 17
    s_mul_i32 s73, s72, 3
    s_sub_u32 s73, s62, s73
    s_lshl_b32 s65, s73, 14
    s_and_b32 s72, s72, 1
    s_cmp_lt_u32 s62, 12
    s_cselect_b32 s72, s72, 0
    s_mul_i32 s72, s72, 81920
    s_add_u32 s65, s65, s72
    v_add_u32 v28, s65, v16
    v_xor_b32 v29, 32, v28
    v_xor_b32 v30, 64, v28
    v_xor_b32 v31, 96, v28
    v_xor_b32 v32, 128, v28
    v_xor_b32 v33, 160, v28
    v_xor_b32 v34, 192, v28
    v_xor_b32 v35, 224, v28
    s_add_u32 s72, s42, 40
    s_sub_u32 s73, s42, 12
    s_cmp_lt_u32 s42, 12
    s_cselect_b32 s72, s72, s73
    s_lshl_b32 s73, s72, 11
    s_lshl_b32 s72, s72, 7
    v_add_u32 v23, s73, v18
    v_add_u32 v24, s72, v19
    s_add_u32 s67, s62, 1
    s_mul_i32 s67, s67, 2
    s_add_u32 s74, s62, 2
    s_cmp_ge_u32 s74, 64
    s_cselect_b32 s74, 128, s74
    s_cmp_ge_u32 s68, s67
    s_cbranch_scc1 L_go_4
L_poll_3:
    ds_read_b32 v39, v14 offset:0
    s_waitcnt lgkmcnt(0)
    v_readfirstlane_b32 s68, v39
    s_nop 0
    s_cmp_ge_u32 s68, s67
    s_cbranch_scc1 L_go_4
    s_sleep 1
    s_sub_u32 s71, s71, 1
    s_cbranch_scc1 L_end
    s_branch L_poll_3
L_go_4:
    ds_read_b128 v[128:131], v28 offset:0
    ds_read_b128 v[132:135], v29 offset:0
    ds_read_b128 v[136:139], v30 offset:0
    ds_read_b128 v[140:143], v31 offset:0
    ds_read_b128 v[144:147], v32 offset:0
    ds_read_b128 v[148:151], v33 offset:0
    ds_read_b128 v[152:155], v34 offset:0
    ds_read_b128 v[156:159], v35 offset:0
    ds_read_b128 v[160:163], v28 offset:256
    ds_read_b128 v[164:167], v29 offset:256
    ds_read_b128 v[168:171], v30 offset:256
    ds_read_b128 v[172:175], v31 offset:256
    ds_read_b128 v[176:179], v32 offset:256
    ds_read_b128 v[180:183], v33 offset:256
    ds_read_b128 v[184:187], v34 offset:256
    ds_read_b128 v[188:191], v35 offset:256
    v_mov_b32 v39, s74
    s_waitcnt lgkmcnt(15)
    v_mfma_f32_32x32x16_bf16 v[48:63], v[128:131], v[192:195], 0
    s_waitcnt lgkmcnt(14)
    v_mfma_f32_32x32x16_bf16 v[48:63], v[132:135], v[196:199], v[48:63]
    s_waitcnt lgkmcnt(13)
    v_mfma_f32_32x32x16_bf16 v[48:63], v[136:139], v[200:203], v[48:63]
    s_waitcnt lgkmcnt(12)
    v_mfma_f32_32x32x16_bf16 v[48:63], v[140:143], v[204:207], v[48:63]
    s_waitcnt lgkmcnt(11)
    v_mfma_f32_32x32x16_bf16 v[48:63], v[144:147], v[208:211], v[48:63]
    s_waitcnt lgkmcnt(10)
    v_mfma_f32_32x32x16_bf16 v[48:63], v[148:151], v[212:215], v[48:63]
    s_waitcnt lgkmcnt(9)
    v_mfma_f32_32x32x16_bf16 v[48:63], v[152:155], v[216:219], v[48:63]
    s_waitcnt lgkmcnt(8)
    v_mfma_f32_32x32x16_bf16 v[48:63], v[156:159], v[220:223], v[48:63]
    s_waitcnt lgkmcnt(0)
    ds_write_b32 v15, v39
    v_mfma_f32_32x32x16_bf16 v[48:63], v[160:163], v[224:227], v[48:63]
    v_mfma_f32_32x32x16_bf16 v[48:63], v[164:167], v[228:231], v[48:63]
    v_mfma_f32_32x32x16_bf16 v[48:63], v[168:171], v[232:235], v[48:63]
    v_mfma_f32_32x32x16_bf16 v[48:63], v[172:175], v[236:239], v[48:63]
    v_mfma_f32_32x32x16_bf16 v[48:63], v[176:179], v[240:243], v[48:63]
    v_mfma_f32_32x32x16_bf16 v[48:63], v[180:183], v[244:247], v[48:63]
    v_mfma_f32_32x32x16_bf16 v[48:63], v[184:187], v[248:251], v[48:63]
    v_mfma_f32_32x32x16_bf16 v[48:63], v[188:191], v[252:255], v[48:63]
    s_add_u32 s70, s70, 1
    v_mov_b32 v38, s70
    s_nop 15
    v_max3_f32 v2, v48, v49, v50
    v_max3_f32 v3, v51, v52, v53
    v_max3_f32 v4, v54, v55, v56
    v_max3_f32 v5, v57, v58, v59
    v_max3_f32 v2, v2, v60, v61
    v_max3_f32 v3, v3, v62, v63
    v_max3_f32 v2, v2, v3, v4
    v_max_f32 v2, v2, v5
    v_mov_b32 v3, v2
    s_nop 1
    v_permlane32_swap_b32 v2, v3
    s_nop 1
    v_max_f32 v2, v2, v3
    v_mul_f32 v2, s63, v2
    v_max_f32 v2, v2, v10
    v_sub_f32 v3, v10, v2
    v_mov_b32 v10, v2
    v_exp_f32 v12, v3
    v_fma_f32 v48, v48, s63, -v10
    v_fma_f32 v49, v49, s63, -v10
    v_fma_f32 v50, v50, s63, -v10
    v_fma_f32 v51, v51, s63, -v10
    v_fma_f32 v52, v52, s63, -v10
    v_fma_f32 v53, v53, s63, -v10
    v_fma_f32 v54, v54, s63, -v10
    v_fma_f32 v55, v55, s63, -v10
    v_fma_f32 v56, v56, s63, -v10
    v_fma_f32 v57, v57, s63, -v10
    v_fma_f32 v58, v58, s63, -v10
    v_fma_f32 v59, v59, s63, -v10
    v_fma_f32 v60, v60, s63, -v10
    v_fma_f32 v61, v61, s63, -v10
    v_fma_f32 v62, v62, s63, -v10
    v_fma_f32 v63, v63, s63, -v10
    v_exp_f32 v48, v48
    v_exp_f32 v49, v49
    v_exp_f32 v50, v50
    v_exp_f32 v51, v51
    v_exp_f32 v52, v52
    v_exp_f32 v53, v53
    v_exp_f32 v54, v54
    v_exp_f32 v55, v55
    v_exp_f32 v56, v56
    v_exp_f32 v57, v57
    v_exp_f32 v58, v58
    v_exp_f32 v59, v59
    v_exp_f32 v60, v60
    v_exp_f32 v61, v61
    v_exp_f32 v62, v62
    v_exp_f32 v63, v63
    s_nop 0
    v_cvt_pk_bf16_f32 v40, v48, v49
    v_cvt_pk_bf16_f32 v41, v50, v51
    v_cvt_pk_bf16_f32 v42, v52, v53
    v_cvt_pk_bf16_f32 v43, v54, v55
    v_cvt_pk_bf16_f32 v44, v56, v57
    v_cvt_pk_bf16_f32 v45, v58, v59
    v_cvt_pk_bf16_f32 v46, v60, v61
    v_cvt_pk_bf16_f32 v47, v62, v63
    ds_write_b32 v24, v12
    ds_write_b128 v23, v[40:43]
    ds_write_b128 v23, v[44:47] offset:1024
    v_add_f32 v2, v48, v49
    v_add_f32 v3, v50, v51
    v_add_f32 v2, v2, v52
    v_add_f32 v3, v3, v53
    v_add_f32 v2, v2, v54
    v_add_f32 v3, v3, v55
    v_add_f32 v2, v2, v56
    v_add_f32 v3, v3, v57
    v_add_f32 v2, v2, v58
    v_add_f32 v3, v3, v59
    v_add_f32 v2, v2, v60
    v_add_f32 v3, v3, v61
    v_add_f32 v2, v2, v62
    v_add_f32 v3, v3, v63
    v_add_f32 v2, v2, v3
    v_fma_f32 v11, v11, v12, v2
    s_waitcnt lgkmcnt(0)
    ds_write_b32 v25, v38
    s_add_u32 s42, s42, 2
    s_cmp_lt_u32 s42, 64
    s_cbranch_scc1 L_kloop
    v_mov_b32 v4, v10
    v_mov_b32 v2, v11
    v_mov_b32 v3, v2
    s_nop 1
    v_permlane32_swap_b32 v2, v3
    s_nop 1
    v_add_f32 v5, v2, v3
    s_lshl_b32 s72, s66, 8
    s_add_u32 s72, s72, 162368
    v_and_b32 v2, 31, v1
    v_lshlrev_b32 v2, 3, v2
    v_add_u32 v2, s72, v2
    ds_write_b64 v2, v[4:5]
    v_mov_b32 v38, 34
    s_waitcnt lgkmcnt(0)
    ds_write_b32 v25, v38
    s_waitcnt lgkmcnt(0)
    s_endpgm
L_pvwave:
    s_sub_u32 s66, s22, 3
    s_lshl_b32 s72, s66, 2
    s_add_u32 s73, s72, 162320
    v_mov_b32 v15, s73
    v_mov_b32 v39, 16
    ds_write_b32 v15, v39
    v_xor_b32 v5, v4, v3
    v_lshlrev_b32 v5, 4, v5
    v_lshl_or_b32 v5, v3, 9, v5
    v_xor_b32 v144, 0, v5
    v_xor_b32 v145, 32, v5
    v_xor_b32 v146, 64, v5
    v_xor_b32 v147, 96, v5
    v_xor_b32 v148, 4224, v5
    v_xor_b32 v149, 4256, v5
    v_xor_b32 v150, 4288, v5
    v_xor_b32 v151, 4320, v5
    v_lshlrev_b32 v6, 2, v3
    v_xor_b32 v6, v4, v6
    v_lshlrev_b32 v6, 4, v6
    v_lshl_or_b32 v6, v3, 9, v6
    v_xor_b32 v152, 0, v6
    v_xor_b32 v153, 128, v6
    v_xor_b32 v154, 4096, v6
    v_xor_b32 v155, 4224, v6
    s_lshl_b32 s73, s23, 14
    s_lshl_b32 s74, s23, 13
    s_and_b32 s75, s66, 1
    s_mul_i32 s75, s75, 4224
    v_xor_b32 v156, s75, v144
    v_xor_b32 v157, s75, v145
    v_xor_b32 v158, s75, v146
    v_xor_b32 v159, s75, v147
    s_lshr_b32 s76, s66, 1
    s_lshl_b32 s76, s76, 13
    s_lshl_b32 s77, s66, 12
    s_waitcnt lgkmcnt(0)
    s_add_u32 s32, s4, s73
    s_addc_u32 s33, s5, 0
    s_and_b32 s33, s33, 0xffff
    s_mov_b32 s34, 16384
    s_mov_b32 s35, 0x00020000
    s_add_u32 m0, s77, 49152
    s_nop 0
    buffer_load_dwordx4 v156, s[32:35], s76 offen offset:0 nt lds
    buffer_load_dwordx4 v157, s[32:35], s76 offen offset:1024 nt lds
    buffer_load_dwordx4 v158, s[32:35], s76 offen offset:2048 nt lds
    buffer_load_dwordx4 v159, s[32:35], s76 offen offset:3072 nt lds
    s_cmp_lg_u32 s3, 3
    s_cbranch_scc1 L_c_notree0
    s_cmp_lg_u32 s66, 2
    s_cbranch_scc1 L_c_tk_done
    s_add_u32 s36, s10, s74
    s_addc_u32 s37, s11, 0
    s_and_b32 s37, s37, 0xffff
    s_mov_b32 s38, 8192
    s_mov_b32 s39, 0x00020000
    s_mov_b32 m0, 65536
    s_nop 0
    buffer_load_dwordx4 v144, s[36:39], 0 offen offset:0 nt lds
    buffer_load_dwordx4 v145, s[36:39], 0 offen offset:1024 nt lds
    buffer_load_dwordx4 v146, s[36:39], 0 offen offset:2048 nt lds
    buffer_load_dwordx4 v147, s[36:39], 0 offen offset:3072 nt lds
    s_mov_b32 m0, 69632
    s_nop 0
    buffer_load_dwordx4 v148, s[36:39], 0 offen offset:0 nt lds
    buffer_load_dwordx4 v149, s[36:39], 0 offen offset:1024 nt lds
    buffer_load_dwordx4 v150, s[36:39], 0 offen offset:2048 nt lds
    buffer_load_dwordx4 v151, s[36:39], 0 offen offset:3072 nt lds
L_c_tk_done:
    s_cmp_lg_u32 s66, 3
    s_cbranch_scc1 L_c_notree0
    s_add_u32 s36, s12, s74
    s_addc_u32 s37, s13, 0
    s_and_b32 s37, s37, 0xffff
    s_mov_b32 s38, 8192
    s_mov_b32 s39, 0x00020000
    s_mov_b32 m0, 73728
    s_nop 0
    buffer_load_dwordx4 v152, s[36:39], 0 offen offset:0 nt lds
    buffer_load_dwordx4 v153, s[36:39], 0 offen offset:1024 nt lds
    buffer_load_dwordx4 v152, s[36:39], 0 offen offset:2048 nt lds
    buffer_load_dwordx4 v153, s[36:39], 0 offen offset:3072 nt lds
    s_mov_b32 m0, 77824
    s_nop 0
    buffer_load_dwordx4 v154, s[36:39], 0 offen offset:0 nt lds
    buffer_load_dwordx4 v155, s[36:39], 0 offen offset:1024 nt lds
    buffer_load_dwordx4 v154, s[36:39], 0 offen offset:2048 nt lds
    buffer_load_dwordx4 v155, s[36:39], 0 offen offset:3072 nt lds
L_c_notree0:
    s_barrier
    s_add_u32 s48, s16, s73
    s_addc_u32 s49, s17, 0
    s_and_b32 s49, s49, 0xffff
    s_mov_b32 s50, 16384
    s_mov_b32 s51, 0x00020000
    s_mov_b32 s52, s20
    s_and_b32 s53, s21, 0xffff
    s_mov_b32 s54, 67108864
    s_mov_b32 s55, 0x00020000
    s_mov_b32 s56, s18
    s_and_b32 s57, s19, 0xffff
    s_mov_b32 s58, 256
    s_mov_b32 s59, 0x00020000
    v_bfe_u32 v5, v1, 2, 2
    v_lshl_add_u32 v6, v3, 2, v5
    v_lshlrev_b32 v6, 9, v6
    v_lshl_or_b32 v6, v5, 6, v6
    v_bfe_u32 v5, v1, 4, 1
    v_lshl_or_b32 v6, v5, 5, v6
    v_and_b32 v5, 3, v1
    v_lshl_or_b32 v6, v5, 3, v6
    s_and_b32 s72, s66, 1
    s_lshl_b32 s72, s72, 7
    s_lshr_b32 s73, s66, 1
    s_lshl_b32 s73, s73, 8
    s_or_b32 s72, s72, s73
    v_xor_b32 v17, s72, v6
    v_lshlrev_b32 v20, 3, v1
    v_lshlrev_b32 v22, 9, v4
    v_lshl_or_b32 v22, v3, 3, v22
    s_mov_b32 s100, 0
    s_mov_b32 s101, 0
    s_add_u32 s72, s3, 8
    s_lshl_b32 s83, 1, s72
    s_mov_b32 s82, 0
    s_lshl_b32 s60, s23, 18
    s_lshl_b32 s69, s66, 8
    s_add_u32 s69, s69, s60
    s_add_u32 s69, s69, 147456
    v_mov_b32 v64, 0
    v_mov_b32 v65, 0
    v_mov_b32 v66, 0
    v_mov_b32 v67, 0
    v_mov_b32 v68, 0
    v_mov_b32 v69, 0
    v_mov_b32 v70, 0
    v_mov_b32 v71, 0
    v_mov_b32 v72, 0
    v_mov_b32 v73, 0
    v_mov_b32 v74, 0
    v_mov_b32 v75, 0
    v_mov_b32 v76, 0
    v_mov_b32 v77, 0
    v_mov_b32 v78, 0
    v_mov_b32 v79, 0
    v_mov_b32 v80, 0
    v_mov_b32 v81, 0
    v_mov_b32 v82, 0
    v_mov_b32 v83, 0
    v_mov_b32 v84, 0
    v_mov_b32 v85, 0
    v_mov_b32 v86, 0
    v_mov_b32 v87, 0
    v_mov_b32 v88, 0
    v_mov_b32 v89, 0
    v_mov_b32 v90, 0
    v_mov_b32 v91, 0
    v_mov_b32 v92, 0
    v_mov_b32 v93, 0
    v_mov_b32 v94, 0
    v_mov_b32 v95, 0
    v_mov_b32 v96, 0
    v_mov_b32 v97, 0
    v_mov_b32 v98, 0
    v_mov_b32 v99, 0
    v_mov_b32 v100, 0
    v_mov_b32 v101, 0
    v_mov_b32 v102, 0
    v_mov_b32 v103, 0
    v_mov_b32 v104, 0
    v_mov_b32 v105, 0
    v_mov_b32 v106, 0
    v_mov_b32 v107, 0
    v_mov_b32 v108, 0
    v_mov_b32 v109, 0
    v_mov_b32 v110, 0
    v_mov_b32 v111, 0
    v_mov_b32 v112, 0
    v_mov_b32 v113, 0
    v_mov_b32 v114, 0
    v_mov_b32 v115, 0
    v_mov_b32 v116, 0
    v_mov_b32 v117, 0
    v_mov_b32 v118, 0
    v_mov_b32 v119, 0
    v_mov_b32 v120, 0
    v_mov_b32 v121, 0
    v_mov_b32 v122, 0
    v_mov_b32 v123, 0
    v_mov_b32 v124, 0
    v_mov_b32 v125, 0
    v_mov_b32 v126, 0
    v_mov_b32 v127, 0
    v_mov_b32 v38, 1
    s_waitcnt vmcnt(0)
    s_mov_b64 exec, 1
    ds_add_u32 v14, v38 offset:4
    s_mov_b64 exec, -1
    s_cmp_lg_u32 s3, 3
    s_cbranch_scc1 L_v_notree
L_poll_5:
    ds_read_b32 v39, v14 offset:8
    s_waitcnt lgkmcnt(0)
    v_readfirstlane_b32 s100, v39
    s_nop 0
    s_cmp_ge_u32 s100, 1
    s_cbranch_scc1 L_go_6
    s_sleep 2
    s_sub_u32 s71, s71, 1
    s_cbranch_scc1 L_end
    s_branch L_poll_5
L_go_6:
    ds_read_b128 v[40:43], v18 offset:16384
    v_add_u32 v28, 73728, v17
    v_xor_b32 v29, 64, v28
    ds_read_b64_tr_b16 v[128:129], v28 offset:0
    ds_read_b64_tr_b16 v[130:131], v28 offset:4096
    ds_read_b64_tr_b16 v[132:133], v29 offset:0
    ds_read_b64_tr_b16 v[134:135], v29 offset:4096
    s_waitcnt lgkmcnt(0)
    v_mfma_f32_32x32x16_bf16 v[64:79], v[128:131], v[40:43], 0
    v_mfma_f32_32x32x16_bf16 v[80:95], v[132:135], v[40:43], 0
L_v_notree:
    v_mov_b32 v39, 48
    ds_write_b32 v15, v39
    s_xor_b32 s72, s66, 2
    s_or_b32 s72, s72, s2
    s_cmp_lg_u32 s72, 0
    s_cbranch_scc1 L_park
    v_mov_b32 v8, 1
    v_mov_b32 v9, 0
    s_mov_b64 exec, 1
    buffer_atomic_cmpswap v[8:9], v13, s[56:59], 0 offen sc0
    s_mov_b64 exec, -1
    s_waitcnt vmcnt(0)
    v_readfirstlane_b32 s72, v8
    s_nop 0
    s_cmp_eq_u32 s72, 3
    s_cbranch_scc1 L_park
    s_cmp_lg_u32 s72, 0
    s_cbranch_scc1 L_park
    v_lshlrev_b32 v8, 18, v1
    s_mov_b32 s72, 147456
    buffer_store_dword v13, v8, s[52:55], s72 offen sc1
    s_mov_b32 s72, 147712
    buffer_store_dword v13, v8, s[52:55], s72 offen sc1
    s_mov_b32 s72, 147968
    buffer_store_dword v13, v8, s[52:55], s72 offen sc1
    s_mov_b32 s72, 148224
    buffer_store_dword v13, v8, s[52:55], s72 offen sc1
    s_waitcnt vmcnt(0)
    v_mov_b32 v8, 3
    s_mov_b64 exec, 1
    buffer_atomic_swap v8, v13, s[56:59], 0 offen
    s_mov_b64 exec, -1
    s_branch L_park
L_park:
    s_cmp_ge_u32 s100, 7
    s_cbranch_scc1 L_go_8
L_poll_7:
    ds_read_b32 v39, v14 offset:8
    s_waitcnt lgkmcnt(0)
    v_readfirstlane_b32 s100, v39
    s_nop 0
    s_cmp_ge_u32 s100, 7
    s_cbranch_scc1 L_go_8
    s_sleep 4
    s_sub_u32 s71, s71, 1
    s_cbranch_scc1 L_end
    s_branch L_poll_7
L_go_8:
    s_cmp_ge_u32 s101, 7
    s_cbranch_scc1 L_go_10
L_poll_9:
    ds_read_b32 v39, v14 offset:12
    s_waitcnt lgkmcnt(0)
    v_readfirstlane_b32 s101, v39
    s_nop 0
    s_cmp_ge_u32 s101, 7
    s_cbranch_scc1 L_go_10
    s_sleep 4
    s_sub_u32 s71, s71, 1
    s_cbranch_scc1 L_end
    s_branch L_poll_9
L_go_10:
    v_add_u32 v23, 81920, v18
    ds_read_b128 v[144:147], v23 offset:0
    ds_read_b128 v[148:151], v23 offset:1024
    ds_read_b32 v240, v19 offset:5120
    ds_read_b128 v[152:155], v23 offset:2048
    ds_read_b128 v[156:159], v23 offset:3072
    ds_read_b32 v241, v19 offset:5248
    ds_read_b128 v[160:163], v23 offset:4096
    ds_read_b128 v[164:167], v23 offset:5120
    ds_read_b32 v242, v19 offset:5376
    ds_read_b128 v[168:171], v23 offset:6144
    ds_read_b128 v[172:175], v23 offset:7168
    ds_read_b32 v243, v19 offset:5504
    ds_read_b128 v[176:179], v23 offset:8192
    ds_read_b128 v[180:183], v23 offset:9216
    ds_read_b32 v244, v19 offset:5632
    ds_read_b128 v[184:187], v23 offset:10240
    ds_read_b128 v[188:191], v23 offset:11264
    ds_read_b32 v245, v19 offset:5760
    ds_read_b128 v[192:195], v23 offset:12288
    ds_read_b128 v[196:199], v23 offset:13312
    ds_read_b32 v246, v19 offset:5888
    ds_read_b128 v[200:203], v23 offset:14336
    ds_read_b128 v[204:207], v23 offset:15360
    ds_read_b32 v247, v19 offset:6016
    ds_read_b128 v[208:211], v23 offset:16384
    ds_read_b128 v[212:215], v23 offset:17408
    ds_read_b32 v248, v19 offset:6144
    ds_read_b128 v[216:219], v23 offset:18432
    ds_read_b128 v[220:223], v23 offset:19456
    ds_read_b32 v249, v19 offset:6272
    ds_read_b128 v[224:227], v23 offset:20480
    ds_read_b128 v[228:231], v23 offset:21504
    ds_read_b32 v250, v19 offset:6400
    ds_read_b128 v[232:235], v23 offset:22528
    ds_read_b128 v[236:239], v23 offset:23552
    ds_read_b32 v251, v19 offset:6528
    s_waitcnt lgkmcnt(0)
    v_mov_b32 v39, 64
    ds_write_b32 v15, v39
    s_cmp_lg_u32 s66, 2
    s_cbranch_scc1 L_vphase
    s_mov_b32 s67, 64
    s_cmp_ge_u32 s68, s67
    s_cbranch_scc1 L_go_12
L_poll_11:
    ds_read_b32 v39, v14 offset:0
    s_waitcnt lgkmcnt(0)
    v_readfirstlane_b32 s68, v39
    s_nop 0
    s_cmp_ge_u32 s68, s67
    s_cbranch_scc1 L_go_12
    s_sleep 8
    s_sub_u32 s71, s71, 1
    s_cbranch_scc1 L_end
    s_branch L_poll_11
L_go_12:
    s_mov_b64 exec, 1
    buffer_load_dword v38, v13, s[56:59], 0 offen sc1
    s_mov_b64 exec, -1
    s_waitcnt vmcnt(0)
    v_readfirstlane_b32 s72, v38
    s_nop 0
    s_cmp_lg_u32 s72, 3
    s_cbranch_scc1 L_check_loop
L_vphase:
    s_mov_b32 s67, 124
    s_cmp_ge_u32 s68, s67
    s_cbranch_scc1 L_go_14
L_poll_13:
    ds_read_b32 v39, v14 offset:0
    s_waitcnt lgkmcnt(0)
    v_readfirstlane_b32 s68, v39
    s_nop 0
    s_cmp_ge_u32 s68, s67
    s_cbranch_scc1 L_go_14
    s_sleep 8
    s_sub_u32 s71, s71, 1
    s_cbranch_scc1 L_end
    s_branch L_poll_13
L_go_14:
    v_add_u32 v28, 16384, v17
    v_xor_b32 v29, 64, v28
    v_mov_b32 v12, v240
    v_pk_mul_f32 v[64:65], v[64:65], v[12:13] op_sel_hi:[1,0]
    v_pk_mul_f32 v[66:67], v[66:67], v[12:13] op_sel_hi:[1,0]
    v_pk_mul_f32 v[68:69], v[68:69], v[12:13] op_sel_hi:[1,0]
    v_pk_mul_f32 v[70:71], v[70:71], v[12:13] op_sel_hi:[1,0]
    v_pk_mul_f32 v[72:73], v[72:73], v[12:13] op_sel_hi:[1,0]
    v_pk_mul_f32 v[74:75], v[74:75], v[12:13] op_sel_hi:[1,0]
    v_pk_mul_f32 v[76:77], v[76:77], v[12:13] op_sel_hi:[1,0]
    v_pk_mul_f32 v[78:79], v[78:79], v[12:13] op_sel_hi:[1,0]
    v_pk_mul_f32 v[80:81], v[80:81], v[12:13] op_sel_hi:[1,0]
    v_pk_mul_f32 v[82:83], v[82:83], v[12:13] op_sel_hi:[1,0]
    v_pk_mul_f32 v[84:85], v[84:85], v[12:13] op_sel_hi:[1,0]
    v_pk_mul_f32 v[86:87], v[86:87], v[12:13] op_sel_hi:[1,0]
    v_pk_mul_f32 v[88:89], v[88:89], v[12:13] op_sel_hi:[1,0]
    v_pk_mul_f32 v[90:91], v[90:91], v[12:13] op_sel_hi:[1,0]
    v_pk_mul_f32 v[92:93], v[92:93], v[12:13] op_sel_hi:[1,0]
    v_pk_mul_f32 v[94:95], v[94:95], v[12:13] op_sel_hi:[1,0]
    s_cmp_ge_u32 s68, 130
    s_cbranch_scc1 L_go_16
L_poll_15:
    ds_read_b32 v39, v14 offset:0
    s_waitcnt lgkmcnt(0)
    v_readfirstlane_b32 s68, v39
    s_nop 0
    s_cmp_ge_u32 s68, 130
    s_cbranch_scc1 L_go_16
    s_sleep 1
    s_sub_u32 s71, s71, 1
    s_cbranch_scc1 L_end
    s_branch L_poll_15
L_go_16:
    ds_read_b64_tr_b16 v[128:129], v28 offset:0
    ds_read_b64_tr_b16 v[130:131], v28 offset:4096
    ds_read_b64_tr_b16 v[132:133], v29 offset:0
    ds_read_b64_tr_b16 v[134:135], v29 offset:4096
    ds_read_b64_tr_b16 v[136:137], v28 offset:8192
    ds_read_b64_tr_b16 v[138:139], v28 offset:12288
    ds_read_b64_tr_b16 v[140:141], v29 offset:8192
    ds_read_b64_tr_b16 v[142:143], v29 offset:12288
    v_mov_b32 v39, 65
    s_waitcnt lgkmcnt(0)
    ds_write_b32 v15, v39
    v_mfma_f32_32x32x16_bf16 v[64:79], v[128:131], v[144:147], v[64:79]
    v_mfma_f32_32x32x16_bf16 v[80:95], v[132:135], v[144:147], v[80:95]
    v_mfma_f32_32x32x16_bf16 v[64:79], v[136:139], v[148:151], v[64:79]
    v_mfma_f32_32x32x16_bf16 v[80:95], v[140:143], v[148:151], v[80:95]
    v_add_u32 v28, 32768, v17
    v_xor_b32 v29, 64, v28
    v_mov_b32 v12, v241
    v_pk_mul_f32 v[96:97], v[96:97], v[12:13] op_sel_hi:[1,0]
    v_pk_mul_f32 v[98:99], v[98:99], v[12:13] op_sel_hi:[1,0]
    v_pk_mul_f32 v[100:101], v[100:101], v[12:13] op_sel_hi:[1,0]
    v_pk_mul_f32 v[102:103], v[102:103], v[12:13] op_sel_hi:[1,0]
    v_pk_mul_f32 v[104:105], v[104:105], v[12:13] op_sel_hi:[1,0]
    v_pk_mul_f32 v[106:107], v[106:107], v[12:13] op_sel_hi:[1,0]
    v_pk_mul_f32 v[108:109], v[108:109], v[12:13] op_sel_hi:[1,0]
    v_pk_mul_f32 v[110:111], v[110:111], v[12:13] op_sel_hi:[1,0]
    v_pk_mul_f32 v[112:113], v[112:113], v[12:13] op_sel_hi:[1,0]
    v_pk_mul_f32 v[114:115], v[114:115], v[12:13] op_sel_hi:[1,0]
    v_pk_mul_f32 v[116:117], v[116:117], v[12:13] op_sel_hi:[1,0]
    v_pk_mul_f32 v[118:119], v[118:119], v[12:13] op_sel_hi:[1,0]
    v_pk_mul_f32 v[120:121], v[120:121], v[12:13] op_sel_hi:[1,0]
    v_pk_mul_f32 v[122:123], v[122:123], v[12:13] op_sel_hi:[1,0]
    v_pk_mul_f32 v[124:125], v[124:125], v[12:13] op_sel_hi:[1,0]
    v_pk_mul_f32 v[126:127], v[126:127], v[12:13] op_sel_hi:[1,0]
    s_cmp_ge_u32 s68, 132
    s_cbranch_scc1 L_go_18
L_poll_17:
    ds_read_b32 v39, v14 offset:0
    s_waitcnt lgkmcnt(0)
    v_readfirstlane_b32 s68, v39
    s_nop 0
    s_cmp_ge_u32 s68, 132
    s_cbranch_scc1 L_go_18
    s_sleep 1
    s_sub_u32 s71, s71, 1
    s_cbranch_scc1 L_end
    s_branch L_poll_17
L_go_18:
    ds_read_b64_tr_b16 v[128:129], v28 offset:0
    ds_read_b64_tr_b16 v[130:131], v28 offset:4096
    ds_read_b64_tr_b16 v[132:133], v29 offset:0
    ds_read_b64_tr_b16 v[134:135], v29 offset:4096
    ds_read_b64_tr_b16 v[136:137], v28 offset:8192
    ds_read_b64_tr_b16 v[138:139], v28 offset:12288
    ds_read_b64_tr_b16 v[140:141], v29 offset:8192
    ds_read_b64_tr_b16 v[142:143], v29 offset:12288
    v_mov_b32 v39, 66
    s_waitcnt lgkmcnt(0)
    ds_write_b32 v15, v39
    v_mfma_f32_32x32x16_bf16 v[96:111], v[128:131], v[152:155], v[96:111]
    v_mfma_f32_32x32x16_bf16 v[112:127], v[132:135], v[152:155], v[112:127]
    v_mfma_f32_32x32x16_bf16 v[96:111], v[136:139], v[156:159], v[96:111]
    v_mfma_f32_32x32x16_bf16 v[112:127], v[140:143], v[156:159], v[112:127]
    v_add_u32 v28, 0, v17
    v_xor_b32 v29, 64, v28
    v_mov_b32 v12, v242
    v_pk_mul_f32 v[64:65], v[64:65], v[12:13] op_sel_hi:[1,0]
    v_pk_mul_f32 v[66:67], v[66:67], v[12:13] op_sel_hi:[1,0]
    v_pk_mul_f32 v[68:69], v[68:69], v[12:13] op_sel_hi:[1,0]
    v_pk_mul_f32 v[70:71], v[70:71], v[12:13] op_sel_hi:[1,0]
    v_pk_mul_f32 v[72:73], v[72:73], v[12:13] op_sel_hi:[1,0]
    v_pk_mul_f32 v[74:75], v[74:75], v[12:13] op_sel_hi:[1,0]
    v_pk_mul_f32 v[76:77], v[76:77], v[12:13] op_sel_hi:[1,0]
    v_pk_mul_f32 v[78:79], v[78:79], v[12:13] op_sel_hi:[1,0]
    v_pk_mul_f32 v[80:81], v[80:81], v[12:13] op_sel_hi:[1,0]
    v_pk_mul_f32 v[82:83], v[82:83], v[12:13] op_sel_hi:[1,0]
    v_pk_mul_f32 v[84:85], v[84:85], v[12:13] op_sel_hi:[1,0]
    v_pk_mul_f32 v[86:87], v[86:87], v[12:13] op_sel_hi:[1,0]
    v_pk_mul_f32 v[88:89], v[88:89], v[12:13] op_sel_hi:[1,0]
    v_pk_mul_f32 v[90:91], v[90:91], v[12:13] op_sel_hi:[1,0]
    v_pk_mul_f32 v[92:93], v[92:93], v[12:13] op_sel_hi:[1,0]
    v_pk_mul_f32 v[94:95], v[94:95], v[12:13] op_sel_hi:[1,0]
    s_cmp_ge_u32 s68, 134
    s_cbranch_scc1 L_go_20
L_poll_19:
    ds_read_b32 v39, v14 offset:0
    s_waitcnt lgkmcnt(0)
    v_readfirstlane_b32 s68, v39
    s_nop 0
    s_cmp_ge_u32 s68, 134
    s_cbranch_scc1 L_go_20
    s_sleep 1
    s_sub_u32 s71, s71, 1
    s_cbranch_scc1 L_end
    s_branch L_poll_19
L_go_20:
    ds_read_b64_tr_b16 v[128:129], v28 offset:0
    ds_read_b64_tr_b16 v[130:131], v28 offset:4096
    ds_read_b64_tr_b16 v[132:133], v29 offset:0
    ds_read_b64_tr_b16 v[134:135], v29 offset:4096
    ds_read_b64_tr_b16 v[136:137], v28 offset:8192
    ds_read_b64_tr_b16 v[138:139], v28 offset:12288
    ds_read_b64_tr_b16 v[140:141], v29 offset:8192
    ds_read_b64_tr_b16 v[142:143], v29 offset:12288
    v_mov_b32 v39, 67
    s_waitcnt lgkmcnt(0)
    ds_write_b32 v15, v39
    v_mfma_f32_32x32x16_bf16 v[64:79], v[128:131], v[160:163], v[64:79]
    v_mfma_f32_32x32x16_bf16 v[80:95], v[132:135], v[160:163], v[80:95]
    v_mfma_f32_32x32x16_bf16 v[64:79], v[136:139], v[164:167], v[64:79]
    v_mfma_f32_32x32x16_bf16 v[80:95], v[140:143], v[164:167], v[80:95]
    v_add_u32 v28, 16384, v17
    v_xor_b32 v29, 64, v28
    v_mov_b32 v12, v243
    v_pk_mul_f32 v[96:97], v[96:97], v[12:13] op_sel_hi:[1,0]
    v_pk_mul_f32 v[98:99], v[98:99], v[12:13] op_sel_hi:[1,0]
    v_pk_mul_f32 v[100:101], v[100:101], v[12:13] op_sel_hi:[1,0]
    v_pk_mul_f32 v[102:103], v[102:103], v[12:13] op_sel_hi:[1,0]
    v_pk_mul_f32 v[104:105], v[104:105], v[12:13] op_sel_hi:[1,0]
    v_pk_mul_f32 v[106:107], v[106:107], v[12:13] op_sel_hi:[1,0]
    v_pk_mul_f32 v[108:109], v[108:109], v[12:13] op_sel_hi:[1,0]
    v_pk_mul_f32 v[110:111], v[110:111], v[12:13] op_sel_hi:[1,0]
    v_pk_mul_f32 v[112:113], v[112:113], v[12:13] op_sel_hi:[1,0]
    v_pk_mul_f32 v[114:115], v[114:115], v[12:13] op_sel_hi:[1,0]
    v_pk_mul_f32 v[116:117], v[116:117], v[12:13] op_sel_hi:[1,0]
    v_pk_mul_f32 v[118:119], v[118:119], v[12:13] op_sel_hi:[1,0]
    v_pk_mul_f32 v[120:121], v[120:121], v[12:13] op_sel_hi:[1,0]
    v_pk_mul_f32 v[122:123], v[122:123], v[12:13] op_sel_hi:[1,0]
    v_pk_mul_f32 v[124:125], v[124:125], v[12:13] op_sel_hi:[1,0]
    v_pk_mul_f32 v[126:127], v[126:127], v[12:13] op_sel_hi:[1,0]
    s_cmp_ge_u32 s68, 136
    s_cbranch_scc1 L_go_22
L_poll_21:
    ds_read_b32 v39, v14 offset:0
    s_waitcnt lgkmcnt(0)
    v_readfirstlane_b32 s68, v39
    s_nop 0
    s_cmp_ge_u32 s68, 136
    s_cbranch_scc1 L_go_22
    s_sleep 1
    s_sub_u32 s71, s71, 1
    s_cbranch_scc1 L_end
    s_branch L_poll_21
L_go_22:
    ds_read_b64_tr_b16 v[128:129], v28 offset:0
    ds_read_b64_tr_b16 v[130:131], v28 offset:4096
    ds_read_b64_tr_b16 v[132:133], v29 offset:0
    ds_read_b64_tr_b16 v[134:135], v29 offset:4096
    ds_read_b64_tr_b16 v[136:137], v28 offset:8192
    ds_read_b64_tr_b16 v[138:139], v28 offset:12288
    ds_read_b64_tr_b16 v[140:141], v29 offset:8192
    ds_read_b64_tr_b16 v[142:143], v29 offset:12288
    v_mov_b32 v39, 68
    s_waitcnt lgkmcnt(0)
    ds_write_b32 v15, v39
    v_mfma_f32_32x32x16_bf16 v[96:111], v[128:131], v[168:171], v[96:111]
    v_mfma_f32_32x32x16_bf16 v[112:127], v[132:135], v[168:171], v[112:127]
    v_mfma_f32_32x32x16_bf16 v[96:111], v[136:139], v[172:175], v[96:111]
    v_mfma_f32_32x32x16_bf16 v[112:127], v[140:143], v[172:175], v[112:127]
    v_add_u32 v28, 32768, v17
    v_xor_b32 v29, 64, v28
    v_mov_b32 v12, v244
    v_pk_mul_f32 v[64:65], v[64:65], v[12:13] op_sel_hi:[1,0]
    v_pk_mul_f32 v[66:67], v[66:67], v[12:13] op_sel_hi:[1,0]
    v_pk_mul_f32 v[68:69], v[68:69], v[12:13] op_sel_hi:[1,0]
    v_pk_mul_f32 v[70:71], v[70:71], v[12:13] op_sel_hi:[1,0]
    v_pk_mul_f32 v[72:73], v[72:73], v[12:13] op_sel_hi:[1,0]
    v_pk_mul_f32 v[74:75], v[74:75], v[12:13] op_sel_hi:[1,0]
    v_pk_mul_f32 v[76:77], v[76:77], v[12:13] op_sel_hi:[1,0]
    v_pk_mul_f32 v[78:79], v[78:79], v[12:13] op_sel_hi:[1,0]
    v_pk_mul_f32 v[80:81], v[80:81], v[12:13] op_sel_hi:[1,0]
    v_pk_mul_f32 v[82:83], v[82:83], v[12:13] op_sel_hi:[1,0]
    v_pk_mul_f32 v[84:85], v[84:85], v[12:13] op_sel_hi:[1,0]
    v_pk_mul_f32 v[86:87], v[86:87], v[12:13] op_sel_hi:[1,0]
    v_pk_mul_f32 v[88:89], v[88:89], v[12:13] op_sel_hi:[1,0]
    v_pk_mul_f32 v[90:91], v[90:91], v[12:13] op_sel_hi:[1,0]
    v_pk_mul_f32 v[92:93], v[92:93], v[12:13] op_sel_hi:[1,0]
    v_pk_mul_f32 v[94:95], v[94:95], v[12:13] op_sel_hi:[1,0]
    s_cmp_ge_u32 s68, 138
    s_cbranch_scc1 L_go_24
L_poll_23:
    ds_read_b32 v39, v14 offset:0
    s_waitcnt lgkmcnt(0)
    v_readfirstlane_b32 s68, v39
    s_nop 0
    s_cmp_ge_u32 s68, 138
    s_cbranch_scc1 L_go_24
    s_sleep 1
    s_sub_u32 s71, s71, 1
    s_cbranch_scc1 L_end
    s_branch L_poll_23
L_go_24:
    ds_read_b64_tr_b16 v[128:129], v28 offset:0
    ds_read_b64_tr_b16 v[130:131], v28 offset:4096
    ds_read_b64_tr_b16 v[132:133], v29 offset:0
    ds_read_b64_tr_b16 v[134:135], v29 offset:4096
    ds_read_b64_tr_b16 v[136:137], v28 offset:8192
    ds_read_b64_tr_b16 v[138:139], v28 offset:12288
    ds_read_b64_tr_b16 v[140:141], v29 offset:8192
    ds_read_b64_tr_b16 v[142:143], v29 offset:12288
    v_mov_b32 v39, 69
    s_waitcnt lgkmcnt(0)
    ds_write_b32 v15, v39
    v_mfma_f32_32x32x16_bf16 v[64:79], v[128:131], v[176:179], v[64:79]
    v_mfma_f32_32x32x16_bf16 v[80:95], v[132:135], v[176:179], v[80:95]
    v_mfma_f32_32x32x16_bf16 v[64:79], v[136:139], v[180:183], v[64:79]
    v_mfma_f32_32x32x16_bf16 v[80:95], v[140:143], v[180:183], v[80:95]
    v_add_u32 v28, 0, v17
    v_xor_b32 v29, 64, v28
    v_mov_b32 v12, v245
    v_pk_mul_f32 v[96:97], v[96:97], v[12:13] op_sel_hi:[1,0]
    v_pk_mul_f32 v[98:99], v[98:99], v[12:13] op_sel_hi:[1,0]
    v_pk_mul_f32 v[100:101], v[100:101], v[12:13] op_sel_hi:[1,0]
    v_pk_mul_f32 v[102:103], v[102:103], v[12:13] op_sel_hi:[1,0]
    v_pk_mul_f32 v[104:105], v[104:105], v[12:13] op_sel_hi:[1,0]
    v_pk_mul_f32 v[106:107], v[106:107], v[12:13] op_sel_hi:[1,0]
    v_pk_mul_f32 v[108:109], v[108:109], v[12:13] op_sel_hi:[1,0]
    v_pk_mul_f32 v[110:111], v[110:111], v[12:13] op_sel_hi:[1,0]
    v_pk_mul_f32 v[112:113], v[112:113], v[12:13] op_sel_hi:[1,0]
    v_pk_mul_f32 v[114:115], v[114:115], v[12:13] op_sel_hi:[1,0]
    v_pk_mul_f32 v[116:117], v[116:117], v[12:13] op_sel_hi:[1,0]
    v_pk_mul_f32 v[118:119], v[118:119], v[12:13] op_sel_hi:[1,0]
    v_pk_mul_f32 v[120:121], v[120:121], v[12:13] op_sel_hi:[1,0]
    v_pk_mul_f32 v[122:123], v[122:123], v[12:13] op_sel_hi:[1,0]
    v_pk_mul_f32 v[124:125], v[124:125], v[12:13] op_sel_hi:[1,0]
    v_pk_mul_f32 v[126:127], v[126:127], v[12:13] op_sel_hi:[1,0]
    s_cmp_ge_u32 s68, 140
    s_cbranch_scc1 L_go_26
L_poll_25:
    ds_read_b32 v39, v14 offset:0
    s_waitcnt lgkmcnt(0)
    v_readfirstlane_b32 s68, v39
    s_nop 0
    s_cmp_ge_u32 s68, 140
    s_cbranch_scc1 L_go_26
    s_sleep 1
    s_sub_u32 s71, s71, 1
    s_cbranch_scc1 L_end
    s_branch L_poll_25
L_go_26:
    ds_read_b64_tr_b16 v[128:129], v28 offset:0
    ds_read_b64_tr_b16 v[130:131], v28 offset:4096
    ds_read_b64_tr_b16 v[132:133], v29 offset:0
    ds_read_b64_tr_b16 v[134:135], v29 offset:4096
    ds_read_b64_tr_b16 v[136:137], v28 offset:8192
    ds_read_b64_tr_b16 v[138:139], v28 offset:12288
    ds_read_b64_tr_b16 v[140:141], v29 offset:8192
    ds_read_b64_tr_b16 v[142:143], v29 offset:12288
    v_mov_b32 v39, 70
    s_waitcnt lgkmcnt(0)
    ds_write_b32 v15, v39
    v_mfma_f32_32x32x16_bf16 v[96:111], v[128:131], v[184:187], v[96:111]
    v_mfma_f32_32x32x16_bf16 v[112:127], v[132:135], v[184:187], v[112:127]
    v_mfma_f32_32x32x16_bf16 v[96:111], v[136:139], v[188:191], v[96:111]
    v_mfma_f32_32x32x16_bf16 v[112:127], v[140:143], v[188:191], v[112:127]
    v_add_u32 v28, 16384, v17
    v_xor_b32 v29, 64, v28
    v_mov_b32 v12, v246
    v_pk_mul_f32 v[64:65], v[64:65], v[12:13] op_sel_hi:[1,0]
    v_pk_mul_f32 v[66:67], v[66:67], v[12:13] op_sel_hi:[1,0]
    v_pk_mul_f32 v[68:69], v[68:69], v[12:13] op_sel_hi:[1,0]
    v_pk_mul_f32 v[70:71], v[70:71], v[12:13] op_sel_hi:[1,0]
    v_pk_mul_f32 v[72:73], v[72:73], v[12:13] op_sel_hi:[1,0]
    v_pk_mul_f32 v[74:75], v[74:75], v[12:13] op_sel_hi:[1,0]
    v_pk_mul_f32 v[76:77], v[76:77], v[12:13] op_sel_hi:[1,0]
    v_pk_mul_f32 v[78:79], v[78:79], v[12:13] op_sel_hi:[1,0]
    v_pk_mul_f32 v[80:81], v[80:81], v[12:13] op_sel_hi:[1,0]
    v_pk_mul_f32 v[82:83], v[82:83], v[12:13] op_sel_hi:[1,0]
    v_pk_mul_f32 v[84:85], v[84:85], v[12:13] op_sel_hi:[1,0]
    v_pk_mul_f32 v[86:87], v[86:87], v[12:13] op_sel_hi:[1,0]
    v_pk_mul_f32 v[88:89], v[88:89], v[12:13] op_sel_hi:[1,0]
    v_pk_mul_f32 v[90:91], v[90:91], v[12:13] op_sel_hi:[1,0]
    v_pk_mul_f32 v[92:93], v[92:93], v[12:13] op_sel_hi:[1,0]
    v_pk_mul_f32 v[94:95], v[94:95], v[12:13] op_sel_hi:[1,0]
    s_cmp_ge_u32 s68, 142
    s_cbranch_scc1 L_go_28
L_poll_27:
    ds_read_b32 v39, v14 offset:0
    s_waitcnt lgkmcnt(0)
    v_readfirstlane_b32 s68, v39
    s_nop 0
    s_cmp_ge_u32 s68, 142
    s_cbranch_scc1 L_go_28
    s_sleep 1
    s_sub_u32 s71, s71, 1
    s_cbranch_scc1 L_end
    s_branch L_poll_27
L_go_28:
    ds_read_b64_tr_b16 v[128:129], v28 offset:0
    ds_read_b64_tr_b16 v[130:131], v28 offset:4096
    ds_read_b64_tr_b16 v[132:133], v29 offset:0
    ds_read_b64_tr_b16 v[134:135], v29 offset:4096
    ds_read_b64_tr_b16 v[136:137], v28 offset:8192
    ds_read_b64_tr_b16 v[138:139], v28 offset:12288
    ds_read_b64_tr_b16 v[140:141], v29 offset:8192
    ds_read_b64_tr_b16 v[142:143], v29 offset:12288
    v_mov_b32 v39, 71
    s_waitcnt lgkmcnt(0)
    ds_write_b32 v15, v39
    v_mfma_f32_32x32x16_bf16 v[64:79], v[128:131], v[192:195], v[64:79]
    v_mfma_f32_32x32x16_bf16 v[80:95], v[132:135], v[192:195], v[80:95]
    v_mfma_f32_32x32x16_bf16 v[64:79], v[136:139], v[196:199], v[64:79]
    v_mfma_f32_32x32x16_bf16 v[80:95], v[140:143], v[196:199], v[80:95]
    v_add_u32 v28, 32768, v17
    v_xor_b32 v29, 64, v28
    v_mov_b32 v12, v247
    v_pk_mul_f32 v[96:97], v[96:97], v[12:13] op_sel_hi:[1,0]
    v_pk_mul_f32 v[98:99], v[98:99], v[12:13] op_sel_hi:[1,0]
    v_pk_mul_f32 v[100:101], v[100:101], v[12:13] op_sel_hi:[1,0]
    v_pk_mul_f32 v[102:103], v[102:103], v[12:13] op_sel_hi:[1,0]
    v_pk_mul_f32 v[104:105], v[104:105], v[12:13] op_sel_hi:[1,0]
    v_pk_mul_f32 v[106:107], v[106:107], v[12:13] op_sel_hi:[1,0]
    v_pk_mul_f32 v[108:109], v[108:109], v[12:13] op_sel_hi:[1,0]
    v_pk_mul_f32 v[110:111], v[110:111], v[12:13] op_sel_hi:[1,0]
    v_pk_mul_f32 v[112:113], v[112:113], v[12:13] op_sel_hi:[1,0]
    v_pk_mul_f32 v[114:115], v[114:115], v[12:13] op_sel_hi:[1,0]
    v_pk_mul_f32 v[116:117], v[116:117], v[12:13] op_sel_hi:[1,0]
    v_pk_mul_f32 v[118:119], v[118:119], v[12:13] op_sel_hi:[1,0]
    v_pk_mul_f32 v[120:121], v[120:121], v[12:13] op_sel_hi:[1,0]
    v_pk_mul_f32 v[122:123], v[122:123], v[12:13] op_sel_hi:[1,0]
    v_pk_mul_f32 v[124:125], v[124:125], v[12:13] op_sel_hi:[1,0]
    v_pk_mul_f32 v[126:127], v[126:127], v[12:13] op_sel_hi:[1,0]
    s_cmp_ge_u32 s68, 144
    s_cbranch_scc1 L_go_30
L_poll_29:
    ds_read_b32 v39, v14 offset:0
    s_waitcnt lgkmcnt(0)
    v_readfirstlane_b32 s68, v39
    s_nop 0
    s_cmp_ge_u32 s68, 144
    s_cbranch_scc1 L_go_30
    s_sleep 1
    s_sub_u32 s71, s71, 1
    s_cbranch_scc1 L_end
    s_branch L_poll_29
L_go_30:
    ds_read_b64_tr_b16 v[128:129], v28 offset:0
    ds_read_b64_tr_b16 v[130:131], v28 offset:4096
    ds_read_b64_tr_b16 v[132:133], v29 offset:0
    ds_read_b64_tr_b16 v[134:135], v29 offset:4096
    ds_read_b64_tr_b16 v[136:137], v28 offset:8192
    ds_read_b64_tr_b16 v[138:139], v28 offset:12288
    ds_read_b64_tr_b16 v[140:141], v29 offset:8192
    ds_read_b64_tr_b16 v[142:143], v29 offset:12288
    v_mov_b32 v39, 72
    s_waitcnt lgkmcnt(0)
    ds_write_b32 v15, v39
    v_mfma_f32_32x32x16_bf16 v[96:111], v[128:131], v[200:203], v[96:111]
    v_mfma_f32_32x32x16_bf16 v[112:127], v[132:135], v[200:203], v[112:127]
    v_mfma_f32_32x32x16_bf16 v[96:111], v[136:139], v[204:207], v[96:111]
    v_mfma_f32_32x32x16_bf16 v[112:127], v[140:143], v[204:207], v[112:127]
    v_add_u32 v28, 0, v17
    v_xor_b32 v29, 64, v28
    v_mov_b32 v12, v248
    v_pk_mul_f32 v[64:65], v[64:65], v[12:13] op_sel_hi:[1,0]
    v_pk_mul_f32 v[66:67], v[66:67], v[12:13] op_sel_hi:[1,0]
    v_pk_mul_f32 v[68:69], v[68:69], v[12:13] op_sel_hi:[1,0]
    v_pk_mul_f32 v[70:71], v[70:71], v[12:13] op_sel_hi:[1,0]
    v_pk_mul_f32 v[72:73], v[72:73], v[12:13] op_sel_hi:[1,0]
    v_pk_mul_f32 v[74:75], v[74:75], v[12:13] op_sel_hi:[1,0]
    v_pk_mul_f32 v[76:77], v[76:77], v[12:13] op_sel_hi:[1,0]
    v_pk_mul_f32 v[78:79], v[78:79], v[12:13] op_sel_hi:[1,0]
    v_pk_mul_f32 v[80:81], v[80:81], v[12:13] op_sel_hi:[1,0]
    v_pk_mul_f32 v[82:83], v[82:83], v[12:13] op_sel_hi:[1,0]
    v_pk_mul_f32 v[84:85], v[84:85], v[12:13] op_sel_hi:[1,0]
    v_pk_mul_f32 v[86:87], v[86:87], v[12:13] op_sel_hi:[1,0]
    v_pk_mul_f32 v[88:89], v[88:89], v[12:13] op_sel_hi:[1,0]
    v_pk_mul_f32 v[90:91], v[90:91], v[12:13] op_sel_hi:[1,0]
    v_pk_mul_f32 v[92:93], v[92:93], v[12:13] op_sel_hi:[1,0]
    v_pk_mul_f32 v[94:95], v[94:95], v[12:13] op_sel_hi:[1,0]
    s_cmp_ge_u32 s68, 146
    s_cbranch_scc1 L_go_32
L_poll_31:
    ds_read_b32 v39, v14 offset:0
    s_waitcnt lgkmcnt(0)
    v_readfirstlane_b32 s68, v39
    s_nop 0
    s_cmp_ge_u32 s68, 146
    s_cbranch_scc1 L_go_32
    s_sleep 1
    s_sub_u32 s71, s71, 1
    s_cbranch_scc1 L_end
    s_branch L_poll_31
L_go_32:
    ds_read_b64_tr_b16 v[128:129], v28 offset:0
    ds_read_b64_tr_b16 v[130:131], v28 offset:4096
    ds_read_b64_tr_b16 v[132:133], v29 offset:0
    ds_read_b64_tr_b16 v[134:135], v29 offset:4096
    ds_read_b64_tr_b16 v[136:137], v28 offset:8192
    ds_read_b64_tr_b16 v[138:139], v28 offset:12288
    ds_read_b64_tr_b16 v[140:141], v29 offset:8192
    ds_read_b64_tr_b16 v[142:143], v29 offset:12288
    v_mov_b32 v39, 73
    s_waitcnt lgkmcnt(0)
    ds_write_b32 v15, v39
    v_mfma_f32_32x32x16_bf16 v[64:79], v[128:131], v[208:211], v[64:79]
    v_mfma_f32_32x32x16_bf16 v[80:95], v[132:135], v[208:211], v[80:95]
    v_mfma_f32_32x32x16_bf16 v[64:79], v[136:139], v[212:215], v[64:79]
    v_mfma_f32_32x32x16_bf16 v[80:95], v[140:143], v[212:215], v[80:95]
    v_add_u32 v28, 16384, v17
    v_xor_b32 v29, 64, v28
    v_mov_b32 v12, v249
    v_pk_mul_f32 v[96:97], v[96:97], v[12:13] op_sel_hi:[1,0]
    v_pk_mul_f32 v[98:99], v[98:99], v[12:13] op_sel_hi:[1,0]
    v_pk_mul_f32 v[100:101], v[100:101], v[12:13] op_sel_hi:[1,0]
    v_pk_mul_f32 v[102:103], v[102:103], v[12:13] op_sel_hi:[1,0]
    v_pk_mul_f32 v[104:105], v[104:105], v[12:13] op_sel_hi:[1,0]
    v_pk_mul_f32 v[106:107], v[106:107], v[12:13] op_sel_hi:[1,0]
    v_pk_mul_f32 v[108:109], v[108:109], v[12:13] op_sel_hi:[1,0]
    v_pk_mul_f32 v[110:111], v[110:111], v[12:13] op_sel_hi:[1,0]
    v_pk_mul_f32 v[112:113], v[112:113], v[12:13] op_sel_hi:[1,0]
    v_pk_mul_f32 v[114:115], v[114:115], v[12:13] op_sel_hi:[1,0]
    v_pk_mul_f32 v[116:117], v[116:117], v[12:13] op_sel_hi:[1,0]
    v_pk_mul_f32 v[118:119], v[118:119], v[12:13] op_sel_hi:[1,0]
    v_pk_mul_f32 v[120:121], v[120:121], v[12:13] op_sel_hi:[1,0]
    v_pk_mul_f32 v[122:123], v[122:123], v[12:13] op_sel_hi:[1,0]
    v_pk_mul_f32 v[124:125], v[124:125], v[12:13] op_sel_hi:[1,0]
    v_pk_mul_f32 v[126:127], v[126:127], v[12:13] op_sel_hi:[1,0]
    s_cmp_ge_u32 s68, 148
    s_cbranch_scc1 L_go_34
L_poll_33:
    ds_read_b32 v39, v14 offset:0
    s_waitcnt lgkmcnt(0)
    v_readfirstlane_b32 s68, v39
    s_nop 0
    s_cmp_ge_u32 s68, 148
    s_cbranch_scc1 L_go_34
    s_sleep 1
    s_sub_u32 s71, s71, 1
    s_cbranch_scc1 L_end
    s_branch L_poll_33
L_go_34:
    ds_read_b64_tr_b16 v[128:129], v28 offset:0
    ds_read_b64_tr_b16 v[130:131], v28 offset:4096
    ds_read_b64_tr_b16 v[132:133], v29 offset:0
    ds_read_b64_tr_b16 v[134:135], v29 offset:4096
    ds_read_b64_tr_b16 v[136:137], v28 offset:8192
    ds_read_b64_tr_b16 v[138:139], v28 offset:12288
    ds_read_b64_tr_b16 v[140:141], v29 offset:8192
    ds_read_b64_tr_b16 v[142:143], v29 offset:12288
    v_mov_b32 v39, 74
    s_waitcnt lgkmcnt(0)
    ds_write_b32 v15, v39
    v_mfma_f32_32x32x16_bf16 v[96:111], v[128:131], v[216:219], v[96:111]
    v_mfma_f32_32x32x16_bf16 v[112:127], v[132:135], v[216:219], v[112:127]
    v_mfma_f32_32x32x16_bf16 v[96:111], v[136:139], v[220:223], v[96:111]
    v_mfma_f32_32x32x16_bf16 v[112:127], v[140:143], v[220:223], v[112:127]
    v_add_u32 v28, 32768, v17
    v_xor_b32 v29, 64, v28
    v_mov_b32 v12, v250
    v_pk_mul_f32 v[64:65], v[64:65], v[12:13] op_sel_hi:[1,0]
    v_pk_mul_f32 v[66:67], v[66:67], v[12:13] op_sel_hi:[1,0]
    v_pk_mul_f32 v[68:69], v[68:69], v[12:13] op_sel_hi:[1,0]
    v_pk_mul_f32 v[70:71], v[70:71], v[12:13] op_sel_hi:[1,0]
    v_pk_mul_f32 v[72:73], v[72:73], v[12:13] op_sel_hi:[1,0]
    v_pk_mul_f32 v[74:75], v[74:75], v[12:13] op_sel_hi:[1,0]
    v_pk_mul_f32 v[76:77], v[76:77], v[12:13] op_sel_hi:[1,0]
    v_pk_mul_f32 v[78:79], v[78:79], v[12:13] op_sel_hi:[1,0]
    v_pk_mul_f32 v[80:81], v[80:81], v[12:13] op_sel_hi:[1,0]
    v_pk_mul_f32 v[82:83], v[82:83], v[12:13] op_sel_hi:[1,0]
    v_pk_mul_f32 v[84:85], v[84:85], v[12:13] op_sel_hi:[1,0]
    v_pk_mul_f32 v[86:87], v[86:87], v[12:13] op_sel_hi:[1,0]
    v_pk_mul_f32 v[88:89], v[88:89], v[12:13] op_sel_hi:[1,0]
    v_pk_mul_f32 v[90:91], v[90:91], v[12:13] op_sel_hi:[1,0]
    v_pk_mul_f32 v[92:93], v[92:93], v[12:13] op_sel_hi:[1,0]
    v_pk_mul_f32 v[94:95], v[94:95], v[12:13] op_sel_hi:[1,0]
    s_cmp_ge_u32 s68, 150
    s_cbranch_scc1 L_go_36
L_poll_35:
    ds_read_b32 v39, v14 offset:0
    s_waitcnt lgkmcnt(0)
    v_readfirstlane_b32 s68, v39
    s_nop 0
    s_cmp_ge_u32 s68, 150
    s_cbranch_scc1 L_go_36
    s_sleep 1
    s_sub_u32 s71, s71, 1
    s_cbranch_scc1 L_end
    s_branch L_poll_35
L_go_36:
    ds_read_b64_tr_b16 v[128:129], v28 offset:0
    ds_read_b64_tr_b16 v[130:131], v28 offset:4096
    ds_read_b64_tr_b16 v[132:133], v29 offset:0
    ds_read_b64_tr_b16 v[134:135], v29 offset:4096
    ds_read_b64_tr_b16 v[136:137], v28 offset:8192
    ds_read_b64_tr_b16 v[138:139], v28 offset:12288
    ds_read_b64_tr_b16 v[140:141], v29 offset:8192
    ds_read_b64_tr_b16 v[142:143], v29 offset:12288
    v_mov_b32 v39, 75
    s_waitcnt lgkmcnt(0)
    ds_write_b32 v15, v39
    v_mfma_f32_32x32x16_bf16 v[64:79], v[128:131], v[224:227], v[64:79]
    v_mfma_f32_32x32x16_bf16 v[80:95], v[132:135], v[224:227], v[80:95]
    v_mfma_f32_32x32x16_bf16 v[64:79], v[136:139], v[228:231], v[64:79]
    v_mfma_f32_32x32x16_bf16 v[80:95], v[140:143], v[228:231], v[80:95]
    v_add_u32 v28, 0, v17
    v_xor_b32 v29, 64, v28
    v_mov_b32 v12, v251
    v_pk_mul_f32 v[96:97], v[96:97], v[12:13] op_sel_hi:[1,0]
    v_pk_mul_f32 v[98:99], v[98:99], v[12:13] op_sel_hi:[1,0]
    v_pk_mul_f32 v[100:101], v[100:101], v[12:13] op_sel_hi:[1,0]
    v_pk_mul_f32 v[102:103], v[102:103], v[12:13] op_sel_hi:[1,0]
    v_pk_mul_f32 v[104:105], v[104:105], v[12:13] op_sel_hi:[1,0]
    v_pk_mul_f32 v[106:107], v[106:107], v[12:13] op_sel_hi:[1,0]
    v_pk_mul_f32 v[108:109], v[108:109], v[12:13] op_sel_hi:[1,0]
    v_pk_mul_f32 v[110:111], v[110:111], v[12:13] op_sel_hi:[1,0]
    v_pk_mul_f32 v[112:113], v[112:113], v[12:13] op_sel_hi:[1,0]
    v_pk_mul_f32 v[114:115], v[114:115], v[12:13] op_sel_hi:[1,0]
    v_pk_mul_f32 v[116:117], v[116:117], v[12:13] op_sel_hi:[1,0]
    v_pk_mul_f32 v[118:119], v[118:119], v[12:13] op_sel_hi:[1,0]
    v_pk_mul_f32 v[120:121], v[120:121], v[12:13] op_sel_hi:[1,0]
    v_pk_mul_f32 v[122:123], v[122:123], v[12:13] op_sel_hi:[1,0]
    v_pk_mul_f32 v[124:125], v[124:125], v[12:13] op_sel_hi:[1,0]
    v_pk_mul_f32 v[126:127], v[126:127], v[12:13] op_sel_hi:[1,0]
    s_cmp_ge_u32 s68, 152
    s_cbranch_scc1 L_go_38
L_poll_37:
    ds_read_b32 v39, v14 offset:0
    s_waitcnt lgkmcnt(0)
    v_readfirstlane_b32 s68, v39
    s_nop 0
    s_cmp_ge_u32 s68, 152
    s_cbranch_scc1 L_go_38
    s_sleep 1
    s_sub_u32 s71, s71, 1
    s_cbranch_scc1 L_end
    s_branch L_poll_37
L_go_38:
    ds_read_b64_tr_b16 v[128:129], v28 offset:0
    ds_read_b64_tr_b16 v[130:131], v28 offset:4096
    ds_read_b64_tr_b16 v[132:133], v29 offset:0
    ds_read_b64_tr_b16 v[134:135], v29 offset:4096
    ds_read_b64_tr_b16 v[136:137], v28 offset:8192
    ds_read_b64_tr_b16 v[138:139], v28 offset:12288
    ds_read_b64_tr_b16 v[140:141], v29 offset:8192
    ds_read_b64_tr_b16 v[142:143], v29 offset:12288
    v_mov_b32 v39, 76
    s_waitcnt lgkmcnt(0)
    ds_write_b32 v15, v39
    v_mfma_f32_32x32x16_bf16 v[96:111], v[128:131], v[232:235], v[96:111]
    v_mfma_f32_32x32x16_bf16 v[112:127], v[132:135], v[232:235], v[112:127]
    v_mfma_f32_32x32x16_bf16 v[96:111], v[136:139], v[236:239], v[96:111]
    v_mfma_f32_32x32x16_bf16 v[112:127], v[140:143], v[236:239], v[112:127]
    s_mov_b32 s42, 12
.p2align 6
L_vloop:
    s_add_u32 s62, s42, 64
    s_mul_i32 s72, s62, 43691
    s_lshr_b32 s72, s72, 17
    s_mul_i32 s73, s72, 3
    s_sub_u32 s73, s62, s73
    s_lshl_b32 s65, s73, 14
    v_add_u32 v28, s65, v17
    v_xor_b32 v29, 64, v28
    s_add_u32 s72, s42, 40
    s_sub_u32 s73, s42, 12
    s_cmp_lt_u32 s42, 12
    s_cselect_b32 s72, s72, s73
    s_lshl_b32 s73, s72, 11
    s_lshl_b32 s72, s72, 7
    v_add_u32 v23, s73, v18
    v_add_u32 v24, s72, v19
    s_lshr_b32 s67, s42, 1
    s_add_u32 s67, s67, 2
    s_cmp_ge_u32 s100, s67
    s_cbranch_scc1 L_go_40
L_poll_39:
    ds_read_b32 v39, v14 offset:8
    s_waitcnt lgkmcnt(0)
    v_readfirstlane_b32 s100, v39
    s_nop 0
    s_cmp_ge_u32 s100, s67
    s_cbranch_scc1 L_go_40
    s_sleep 2
    s_sub_u32 s71, s71, 1
    s_cbranch_scc1 L_end
    s_branch L_poll_39
L_go_40:
    ds_read_b32 v12, v24
    ds_read_b128 v[40:43], v23
    ds_read_b128 v[44:47], v23 offset:1024
    s_cmp_ge_u32 s62, 120
    s_cbranch_scc1 L_hook
L_hook_done:
    s_add_u32 s74, s62, 1
    s_mul_i32 s67, s74, 2
    s_waitcnt lgkmcnt(0)
    v_pk_mul_f32 v[64:65], v[64:65], v[12:13] op_sel_hi:[1,0]
    v_pk_mul_f32 v[66:67], v[66:67], v[12:13] op_sel_hi:[1,0]
    v_pk_mul_f32 v[68:69], v[68:69], v[12:13] op_sel_hi:[1,0]
    v_pk_mul_f32 v[70:71], v[70:71], v[12:13] op_sel_hi:[1,0]
    v_pk_mul_f32 v[72:73], v[72:73], v[12:13] op_sel_hi:[1,0]
    v_pk_mul_f32 v[74:75], v[74:75], v[12:13] op_sel_hi:[1,0]
    v_pk_mul_f32 v[76:77], v[76:77], v[12:13] op_sel_hi:[1,0]
    v_pk_mul_f32 v[78:79], v[78:79], v[12:13] op_sel_hi:[1,0]
    v_pk_mul_f32 v[80:81], v[80:81], v[12:13] op_sel_hi:[1,0]
    v_pk_mul_f32 v[82:83], v[82:83], v[12:13] op_sel_hi:[1,0]
    v_pk_mul_f32 v[84:85], v[84:85], v[12:13] op_sel_hi:[1,0]
    v_pk_mul_f32 v[86:87], v[86:87], v[12:13] op_sel_hi:[1,0]
    v_pk_mul_f32 v[88:89], v[88:89], v[12:13] op_sel_hi:[1,0]
    v_pk_mul_f32 v[90:91], v[90:91], v[12:13] op_sel_hi:[1,0]
    v_pk_mul_f32 v[92:93], v[92:93], v[12:13] op_sel_hi:[1,0]
    v_pk_mul_f32 v[94:95], v[94:95], v[12:13] op_sel_hi:[1,0]
    s_cmp_ge_u32 s68, s67
    s_cbranch_scc1 L_go_42
L_poll_41:
    ds_read_b32 v39, v14 offset:0
    s_waitcnt lgkmcnt(0)
    v_readfirstlane_b32 s68, v39
    s_nop 0
    s_cmp_ge_u32 s68, s67
    s_cbranch_scc1 L_go_42
    s_sleep 1
    s_sub_u32 s71, s71, 1
    s_cbranch_scc1 L_end
    s_branch L_poll_41
L_go_42:
    ds_read_b64_tr_b16 v[128:129], v28 offset:0
    ds_read_b64_tr_b16 v[130:131], v28 offset:4096
    ds_read_b64_tr_b16 v[132:133], v29 offset:0
    ds_read_b64_tr_b16 v[134:135], v29 offset:4096
    ds_read_b64_tr_b16 v[136:137], v28 offset:8192
    ds_read_b64_tr_b16 v[138:139], v28 offset:12288
    ds_read_b64_tr_b16 v[140:141], v29 offset:8192
    ds_read_b64_tr_b16 v[142:143], v29 offset:12288
    v_mov_b32 v39, s74
    s_add_u32 s42, s42, 1
    s_waitcnt lgkmcnt(0)
    ds_write_b32 v15, v39
    v_mfma_f32_32x32x16_bf16 v[64:79], v[128:131], v[40:43], v[64:79]
    v_mfma_f32_32x32x16_bf16 v[80:95], v[132:135], v[40:43], v[80:95]
    v_mfma_f32_32x32x16_bf16 v[64:79], v[136:139], v[44:47], v[64:79]
    v_mfma_f32_32x32x16_bf16 v[80:95], v[140:143], v[44:47], v[80:95]
    s_add_u32 s62, s42, 64
    s_mul_i32 s72, s62, 43691
    s_lshr_b32 s72, s72, 17
    s_mul_i32 s73, s72, 3
    s_sub_u32 s73, s62, s73
    s_lshl_b32 s65, s73, 14
    v_add_u32 v28, s65, v17
    v_xor_b32 v29, 64, v28
    s_add_u32 s72, s42, 40
    s_sub_u32 s73, s42, 12
    s_cmp_lt_u32 s42, 12
    s_cselect_b32 s72, s72, s73
    s_lshl_b32 s73, s72, 11
    s_lshl_b32 s72, s72, 7
    v_add_u32 v23, s73, v18
    v_add_u32 v24, s72, v19
    s_lshr_b32 s67, s42, 1
    s_add_u32 s67, s67, 2
    s_cmp_ge_u32 s101, s67
    s_cbranch_scc1 L_go_44
L_poll_43:
    ds_read_b32 v39, v14 offset:12
    s_waitcnt lgkmcnt(0)
    v_readfirstlane_b32 s101, v39
    s_nop 0
    s_cmp_ge_u32 s101, s67
    s_cbranch_scc1 L_go_44
    s_sleep 2
    s_sub_u32 s71, s71, 1
    s_cbranch_scc1 L_end
    s_branch L_poll_43
L_go_44:
    ds_read_b32 v12, v24
    ds_read_b128 v[40:43], v23
    ds_read_b128 v[44:47], v23 offset:1024
    s_add_u32 s74, s62, 1
    s_mul_i32 s67, s74, 2
    s_waitcnt lgkmcnt(0)
    v_pk_mul_f32 v[96:97], v[96:97], v[12:13] op_sel_hi:[1,0]
    v_pk_mul_f32 v[98:99], v[98:99], v[12:13] op_sel_hi:[1,0]
    v_pk_mul_f32 v[100:101], v[100:101], v[12:13] op_sel_hi:[1,0]
    v_pk_mul_f32 v[102:103], v[102:103], v[12:13] op_sel_hi:[1,0]
    v_pk_mul_f32 v[104:105], v[104:105], v[12:13] op_sel_hi:[1,0]
    v_pk_mul_f32 v[106:107], v[106:107], v[12:13] op_sel_hi:[1,0]
    v_pk_mul_f32 v[108:109], v[108:109], v[12:13] op_sel_hi:[1,0]
    v_pk_mul_f32 v[110:111], v[110:111], v[12:13] op_sel_hi:[1,0]
    v_pk_mul_f32 v[112:113], v[112:113], v[12:13] op_sel_hi:[1,0]
    v_pk_mul_f32 v[114:115], v[114:115], v[12:13] op_sel_hi:[1,0]
    v_pk_mul_f32 v[116:117], v[116:117], v[12:13] op_sel_hi:[1,0]
    v_pk_mul_f32 v[118:119], v[118:119], v[12:13] op_sel_hi:[1,0]
    v_pk_mul_f32 v[120:121], v[120:121], v[12:13] op_sel_hi:[1,0]
    v_pk_mul_f32 v[122:123], v[122:123], v[12:13] op_sel_hi:[1,0]
    v_pk_mul_f32 v[124:125], v[124:125], v[12:13] op_sel_hi:[1,0]
    v_pk_mul_f32 v[126:127], v[126:127], v[12:13] op_sel_hi:[1,0]
    s_cmp_eq_u32 s62, 127
    s_cbranch_scc1 L_scale0
L_scale0_done:
    s_cmp_ge_u32 s68, s67
    s_cbranch_scc1 L_go_46
L_poll_45:
    ds_read_b32 v39, v14 offset:0
    s_waitcnt lgkmcnt(0)
    v_readfirstlane_b32 s68, v39
    s_nop 0
    s_cmp_ge_u32 s68, s67
    s_cbranch_scc1 L_go_46
    s_sleep 1
    s_sub_u32 s71, s71, 1
    s_cbranch_scc1 L_end
    s_branch L_poll_45
L_go_46:
    ds_read_b64_tr_b16 v[128:129], v28 offset:0
    ds_read_b64_tr_b16 v[130:131], v28 offset:4096
    ds_read_b64_tr_b16 v[132:133], v29 offset:0
    ds_read_b64_tr_b16 v[134:135], v29 offset:4096
    ds_read_b64_tr_b16 v[136:137], v28 offset:8192
    ds_read_b64_tr_b16 v[138:139], v28 offset:12288
    ds_read_b64_tr_b16 v[140:141], v29 offset:8192
    ds_read_b64_tr_b16 v[142:143], v29 offset:12288
    v_mov_b32 v39, s74
    s_add_u32 s42, s42, 1
    s_waitcnt lgkmcnt(0)
    ds_write_b32 v15, v39
    v_mfma_f32_32x32x16_bf16 v[96:111], v[128:131], v[40:43], v[96:111]
    v_mfma_f32_32x32x16_bf16 v[112:127], v[132:135], v[40:43], v[112:127]
    v_mfma_f32_32x32x16_bf16 v[96:111], v[136:139], v[44:47], v[96:111]
    v_mfma_f32_32x32x16_bf16 v[112:127], v[140:143], v[44:47], v[112:127]
    s_cmp_lt_u32 s42, 64
    s_cbranch_scc1 L_vloop
    s_nop 7
    s_nop 5
    v_pk_fma_f32 v[64:65], v[96:97], v[36:37], v[64:65] op_sel_hi:[1,0,1]
    v_pk_fma_f32 v[66:67], v[98:99], v[36:37], v[66:67] op_sel_hi:[1,0,1]
    v_pk_fma_f32 v[68:69], v[100:101], v[36:37], v[68:69] op_sel_hi:[1,0,1]
    v_pk_fma_f32 v[70:71], v[102:103], v[36:37], v[70:71] op_sel_hi:[1,0,1]
    v_pk_fma_f32 v[72:73], v[104:105], v[36:37], v[72:73] op_sel_hi:[1,0,1]
    v_pk_fma_f32 v[74:75], v[106:107], v[36:37], v[74:75] op_sel_hi:[1,0,1]
    v_pk_fma_f32 v[76:77], v[108:109], v[36:37], v[76:77] op_sel_hi:[1,0,1]
    v_pk_fma_f32 v[78:79], v[110:111], v[36:37], v[78:79] op_sel_hi:[1,0,1]
    v_pk_fma_f32 v[80:81], v[112:113], v[36:37], v[80:81] op_sel_hi:[1,0,1]
    v_pk_fma_f32 v[82:83], v[114:115], v[36:37], v[82:83] op_sel_hi:[1,0,1]
    v_pk_fma_f32 v[84:85], v[116:117], v[36:37], v[84:85] op_sel_hi:[1,0,1]
    v_pk_fma_f32 v[86:87], v[118:119], v[36:37], v[86:87] op_sel_hi:[1,0,1]
    v_pk_fma_f32 v[88:89], v[120:121], v[36:37], v[88:89] op_sel_hi:[1,0,1]
    v_pk_fma_f32 v[90:91], v[122:123], v[36:37], v[90:91] op_sel_hi:[1,0,1]
    v_pk_fma_f32 v[92:93], v[124:125], v[36:37], v[92:93] op_sel_hi:[1,0,1]
    v_pk_fma_f32 v[94:95], v[126:127], v[36:37], v[94:95] op_sel_hi:[1,0,1]
    v_max3_f32 v48, |v64|, |v65|, |v66|
    v_max3_f32 v49, |v67|, |v68|, |v69|
    v_max3_f32 v50, |v70|, |v71|, |v72|
    v_max3_f32 v51, |v73|, |v74|, |v75|
    v_max3_f32 v52, |v76|, |v77|, |v78|
    v_max3_f32 v53, |v79|, |v80|, |v81|
    v_max3_f32 v54, |v82|, |v83|, |v84|
    v_max3_f32 v55, |v85|, |v86|, |v87|
    v_max3_f32 v56, |v88|, |v89|, |v90|
    v_max3_f32 v57, |v91|, |v92|, |v93|
    v_max3_f32 v48, v48, |v94|, |v95|
    v_max3_f32 v49, v49, v50, v51
    v_max3_f32 v52, v52, v53, v54
    v_max3_f32 v55, v55, v56, v57
    v_max3_f32 v48, v48, v49, v52
    v_max_f32 v48, v48, v55
    v_frexp_exp_i32_f32 v48, v48
    v_sub_u32 v48, 15, v48
    v_min_i32 v48, 100, v48
    v_sub_u32 v49, 0, v48
    v_ldexp_f32 v12, 1.0, v48
    v_ldexp_f32 v114, 1.0, v49
    v_mov_b32 v112, v10
    v_mov_b32 v113, v11
    v_mov_b32 v115, 0
    v_pk_mul_f32 v[64:65], v[64:65], v[12:13] op_sel_hi:[1,0]
    v_pk_mul_f32 v[66:67], v[66:67], v[12:13] op_sel_hi:[1,0]
    v_pk_mul_f32 v[68:69], v[68:69], v[12:13] op_sel_hi:[1,0]
    v_pk_mul_f32 v[70:71], v[70:71], v[12:13] op_sel_hi:[1,0]
    v_pk_mul_f32 v[72:73], v[72:73], v[12:13] op_sel_hi:[1,0]
    v_pk_mul_f32 v[74:75], v[74:75], v[12:13] op_sel_hi:[1,0]
    v_pk_mul_f32 v[76:77], v[76:77], v[12:13] op_sel_hi:[1,0]
    v_pk_mul_f32 v[78:79], v[78:79], v[12:13] op_sel_hi:[1,0]
    v_pk_mul_f32 v[80:81], v[80:81], v[12:13] op_sel_hi:[1,0]
    v_pk_mul_f32 v[82:83], v[82:83], v[12:13] op_sel_hi:[1,0]
    v_pk_mul_f32 v[84:85], v[84:85], v[12:13] op_sel_hi:[1,0]
    v_pk_mul_f32 v[86:87], v[86:87], v[12:13] op_sel_hi:[1,0]
    v_pk_mul_f32 v[88:89], v[88:89], v[12:13] op_sel_hi:[1,0]
    v_pk_mul_f32 v[90:91], v[90:91], v[12:13] op_sel_hi:[1,0]
    v_pk_mul_f32 v[92:93], v[92:93], v[12:13] op_sel_hi:[1,0]
    v_pk_mul_f32 v[94:95], v[94:95], v[12:13] op_sel_hi:[1,0]
    v_cvt_pk_f16_f32 v96, v64, v65
    v_cvt_pk_f16_f32 v97, v66, v67
    v_cvt_pk_f16_f32 v98, v68, v69
    v_cvt_pk_f16_f32 v99, v70, v71
    v_cvt_pk_f16_f32 v100, v72, v73
    v_cvt_pk_f16_f32 v101, v74, v75
    v_cvt_pk_f16_f32 v102, v76, v77
    v_cvt_pk_f16_f32 v103, v78, v79
    v_cvt_pk_f16_f32 v104, v80, v81
    v_cvt_pk_f16_f32 v105, v82, v83
    v_cvt_pk_f16_f32 v106, v84, v85
    v_cvt_pk_f16_f32 v107, v86, v87
    v_cvt_pk_f16_f32 v108, v88, v89
    v_cvt_pk_f16_f32 v109, v90, v91
    v_cvt_pk_f16_f32 v110, v92, v93
    v_cvt_pk_f16_f32 v111, v94, v95
    s_and_b32 s78, s82, 0xff
    s_cmp_ge_u32 s78, 3
    s_cbranch_scc1 L_last
    s_lshl_b32 s72, s3, 2
    s_add_u32 s72, s72, s66
    s_lshl_b32 s73, s72, 12
    s_add_u32 s73, s73, s60
    s_lshl_b32 s75, s72, 10
    s_add_u32 s75, s75, s60
    s_add_u32 s75, s75, 131072
    buffer_store_dwordx4 v[112:115], v21, s[52:55], s75 offen sc1
    buffer_store_dwordx4 v[96:99], v21, s[52:55], s73 offen offset:0 sc1
    buffer_store_dwordx4 v[100:103], v21, s[52:55], s73 offen offset:1024 sc1
    buffer_store_dwordx4 v[104:107], v21, s[52:55], s73 offen offset:2048 sc1
    buffer_store_dwordx4 v[108:111], v21, s[52:55], s73 offen offset:3072 sc1
    v_mov_b32 v38, s83
    s_waitcnt vmcnt(0)
    s_mov_b64 exec, 1
    buffer_atomic_or v38, v13, s[52:55], s69 offen
    s_mov_b64 exec, -1
    s_endpgm
L_last:
    s_cmp_lg_u32 s3, 0
    s_cbranch_scc1 L_own1
    v_mov_b32 v144, v96
    v_mov_b32 v145, v97
    v_mov_b32 v146, v98
    v_mov_b32 v147, v99
    v_mov_b32 v148, v100
    v_mov_b32 v149, v101
    v_mov_b32 v150, v102
    v_mov_b32 v151, v103
    v_mov_b32 v152, v104
    v_mov_b32 v153, v105
    v_mov_b32 v154, v106
    v_mov_b32 v155, v107
    v_mov_b32 v156, v108
    v_mov_b32 v157, v109
    v_mov_b32 v158, v110
    v_mov_b32 v159, v111
    v_mov_b32 v208, v112
    v_mov_b32 v209, v113
    v_mov_b32 v210, v114
    s_branch L_own_done
L_own1:
    s_cmp_lg_u32 s3, 1
    s_cbranch_scc1 L_own2
    v_mov_b32 v160, v96
    v_mov_b32 v161, v97
    v_mov_b32 v162, v98
    v_mov_b32 v163, v99
    v_mov_b32 v164, v100
    v_mov_b32 v165, v101
    v_mov_b32 v166, v102
    v_mov_b32 v167, v103
    v_mov_b32 v168, v104
    v_mov_b32 v169, v105
    v_mov_b32 v170, v106
    v_mov_b32 v171, v107
    v_mov_b32 v172, v108
    v_mov_b32 v173, v109
    v_mov_b32 v174, v110
    v_mov_b32 v175, v111
    v_mov_b32 v212, v112
    v_mov_b32 v213, v113
    v_mov_b32 v214, v114
    s_branch L_own_done
L_own2:
    s_cmp_lg_u32 s3, 2
    s_cbranch_scc1 L_own3
    v_mov_b32 v176, v96
    v_mov_b32 v177, v97
    v_mov_b32 v178, v98
    v_mov_b32 v179, v99
    v_mov_b32 v180, v100
    v_mov_b32 v181, v101
    v_mov_b32 v182, v102
    v_mov_b32 v183, v103
    v_mov_b32 v184, v104
    v_mov_b32 v185, v105
    v_mov_b32 v186, v106
    v_mov_b32 v187, v107
    v_mov_b32 v188, v108
    v_mov_b32 v189, v109
    v_mov_b32 v190, v110
    v_mov_b32 v191, v111
    v_mov_b32 v216, v112
    v_mov_b32 v217, v113
    v_mov_b32 v218, v114
    s_branch L_own_done
L_own3:
    v_mov_b32 v192, v96
    v_mov_b32 v193, v97
    v_mov_b32 v194, v98
    v_mov_b32 v195, v99
    v_mov_b32 v196, v100
    v_mov_b32 v197, v101
    v_mov_b32 v198, v102
    v_mov_b32 v199, v103
    v_mov_b32 v200, v104
    v_mov_b32 v201, v105
    v_mov_b32 v202, v106
    v_mov_b32 v203, v107
    v_mov_b32 v204, v108
    v_mov_b32 v205, v109
    v_mov_b32 v206, v110
    v_mov_b32 v207, v111
    v_mov_b32 v220, v112
    v_mov_b32 v221, v113
    v_mov_b32 v222, v114
L_own_done:
    s_cmp_eq_u32 s83, 0xf00
    s_cbranch_scc1 L_combine
L_wait_done:
    s_waitcnt vmcnt(0)
    v_readfirstlane_b32 s82, v38
    s_nop 0
    s_andn2_b32 s77, s82, s83
    s_and_b32 s77, s77, 256
    s_cbranch_scc0 L_nold_47
    s_or_b32 s83, s83, 256
    s_lshl_b32 s75, s66, 10
    s_add_u32 s75, s75, s60
    s_add_u32 s75, s75, 131072
    buffer_load_dwordx4 v[208:211], v21, s[52:55], s75 offen sc1
    s_lshl_b32 s73, s66, 12
    s_add_u32 s73, s73, s60
    s_add_u32 s73, s73, 0
    buffer_load_dwordx4 v[144:147], v21, s[52:55], s73 offen offset:0 sc1
    buffer_load_dwordx4 v[148:151], v21, s[52:55], s73 offen offset:1024 sc1
    buffer_load_dwordx4 v[152:155], v21, s[52:55], s73 offen offset:2048 sc1
    buffer_load_dwordx4 v[156:159], v21, s[52:55], s73 offen offset:3072 sc1
L_nold_47:
    s_andn2_b32 s77, s82, s83
    s_and_b32 s77, s77, 512
    s_cbranch_scc0 L_nold_48
    s_or_b32 s83, s83, 512
    s_lshl_b32 s75, s66, 10
    s_add_u32 s75, s75, s60
    s_add_u32 s75, s75, 135168
    buffer_load_dwordx4 v[212:215], v21, s[52:55], s75 offen sc1
    s_lshl_b32 s73, s66, 12
    s_add_u32 s73, s73, s60
    s_add_u32 s73, s73, 16384
    buffer_load_dwordx4 v[160:163], v21, s[52:55], s73 offen offset:0 sc1
    buffer_load_dwordx4 v[164:167], v21, s[52:55], s73 offen offset:1024 sc1
    buffer_load_dwordx4 v[168:171], v21, s[52:55], s73 offen offset:2048 sc1
    buffer_load_dwordx4 v[172:175], v21, s[52:55], s73 offen offset:3072 sc1
L_nold_48:
    s_andn2_b32 s77, s82, s83
    s_and_b32 s77, s77, 1024
    s_cbranch_scc0 L_nold_49
    s_or_b32 s83, s83, 1024
    s_lshl_b32 s75, s66, 10
    s_add_u32 s75, s75, s60
    s_add_u32 s75, s75, 139264
    buffer_load_dwordx4 v[216:219], v21, s[52:55], s75 offen sc1
    s_lshl_b32 s73, s66, 12
    s_add_u32 s73, s73, s60
    s_add_u32 s73, s73, 32768
    buffer_load_dwordx4 v[176:179], v21, s[52:55], s73 offen offset:0 sc1
    buffer_load_dwordx4 v[180:183], v21, s[52:55], s73 offen offset:1024 sc1
    buffer_load_dwordx4 v[184:187], v21, s[52:55], s73 offen offset:2048 sc1
    buffer_load_dwordx4 v[188:191], v21, s[52:55], s73 offen offset:3072 sc1
L_nold_49:
    s_andn2_b32 s77, s82, s83
    s_and_b32 s77, s77, 2048
    s_cbranch_scc0 L_nold_50
    s_or_b32 s83, s83, 2048
    s_lshl_b32 s75, s66, 10
    s_add_u32 s75, s75, s60
    s_add_u32 s75, s75, 143360
    buffer_load_dwordx4 v[220:223], v21, s[52:55], s75 offen sc1
    s_lshl_b32 s73, s66, 12
    s_add_u32 s73, s73, s60
    s_add_u32 s73, s73, 49152
    buffer_load_dwordx4 v[192:195], v21, s[52:55], s73 offen offset:0 sc1
    buffer_load_dwordx4 v[196:199], v21, s[52:55], s73 offen offset:1024 sc1
    buffer_load_dwordx4 v[200:203], v21, s[52:55], s73 offen offset:2048 sc1
    buffer_load_dwordx4 v[204:207], v21, s[52:55], s73 offen offset:3072 sc1
L_nold_50:
    s_cmp_eq_u32 s83, 0xf00
    s_cbranch_scc1 L_combine
    s_mov_b64 exec, 1
    buffer_load_dword v38, v13, s[52:55], s69 offen sc1
    s_mov_b64 exec, -1
    s_sub_u32 s71, s71, 1
    s_cbranch_scc1 L_end
    s_branch L_wait_done
L_combine:
    s_lshl_b32 s80, s66, 7
    s_waitcnt vmcnt(4)
    v_max_f32 v2, v208, v212
    v_max3_f32 v10, v2, v216, v220
    v_sub_f32 v48, v208, v10
    v_sub_f32 v49, v212, v10
    v_sub_f32 v50, v216, v10
    v_sub_f32 v51, v220, v10
    v_exp_f32 v48, v48
    v_exp_f32 v49, v49
    v_exp_f32 v50, v50
    v_exp_f32 v51, v51
    s_nop 0
    v_mul_f32 v11, v48, v209
    v_fma_f32 v11, v49, v213, v11
    v_fma_f32 v11, v50, v217, v11
    v_fma_f32 v11, v51, v221, v11
    v_rcp_f32 v12, v11
    v_mul_f32 v48, v48, v210
    v_mul_f32 v49, v49, v214
    v_mul_f32 v50, v50, v218
    v_mul_f32 v51, v51, v222
    v_mul_f32 v48, v48, v12
    v_mul_f32 v49, v49, v12
    v_mul_f32 v50, v50, v12
    v_mul_f32 v51, v51, v12
    s_waitcnt vmcnt(0)
    v_fma_mix_f32 v64, v144, v48, 0 op_sel:[0,0,0] op_sel_hi:[1,0,0]
    v_fma_mix_f32 v65, v144, v48, 0 op_sel:[1,0,0] op_sel_hi:[1,0,0]
    v_fma_mix_f32 v66, v145, v48, 0 op_sel:[0,0,0] op_sel_hi:[1,0,0]
    v_fma_mix_f32 v67, v145, v48, 0 op_sel:[1,0,0] op_sel_hi:[1,0,0]
    v_fma_mix_f32 v64, v160, v49, v64 op_sel:[0,0,0] op_sel_hi:[1,0,0]
    v_fma_mix_f32 v65, v160, v49, v65 op_sel:[1,0,0] op_sel_hi:[1,0,0]
    v_fma_mix_f32 v66, v161, v49, v66 op_sel:[0,0,0] op_sel_hi:[1,0,0]
    v_fma_mix_f32 v67, v161, v49, v67 op_sel:[1,0,0] op_sel_hi:[1,0,0]
    v_fma_mix_f32 v64, v176, v50, v64 op_sel:[0,0,0] op_sel_hi:[1,0,0]
    v_fma_mix_f32 v65, v176, v50, v65 op_sel:[1,0,0] op_sel_hi:[1,0,0]
    v_fma_mix_f32 v66, v177, v50, v66 op_sel:[0,0,0] op_sel_hi:[1,0,0]
    v_fma_mix_f32 v67, v177, v50, v67 op_sel:[1,0,0] op_sel_hi:[1,0,0]
    v_fma_mix_f32 v64, v192, v51, v64 op_sel:[0,0,0] op_sel_hi:[1,0,0]
    v_fma_mix_f32 v65, v192, v51, v65 op_sel:[1,0,0] op_sel_hi:[1,0,0]
    v_fma_mix_f32 v66, v193, v51, v66 op_sel:[0,0,0] op_sel_hi:[1,0,0]
    v_fma_mix_f32 v67, v193, v51, v67 op_sel:[1,0,0] op_sel_hi:[1,0,0]
    v_cvt_pk_bf16_f32 v96, v64, v65
    v_cvt_pk_bf16_f32 v97, v66, v67
    buffer_store_dwordx2 v[96:97], v22, s[48:51], s80 offen offset:0
    v_fma_mix_f32 v68, v146, v48, 0 op_sel:[0,0,0] op_sel_hi:[1,0,0]
    v_fma_mix_f32 v69, v146, v48, 0 op_sel:[1,0,0] op_sel_hi:[1,0,0]
    v_fma_mix_f32 v70, v147, v48, 0 op_sel:[0,0,0] op_sel_hi:[1,0,0]
    v_fma_mix_f32 v71, v147, v48, 0 op_sel:[1,0,0] op_sel_hi:[1,0,0]
    v_fma_mix_f32 v68, v162, v49, v68 op_sel:[0,0,0] op_sel_hi:[1,0,0]
    v_fma_mix_f32 v69, v162, v49, v69 op_sel:[1,0,0] op_sel_hi:[1,0,0]
    v_fma_mix_f32 v70, v163, v49, v70 op_sel:[0,0,0] op_sel_hi:[1,0,0]
    v_fma_mix_f32 v71, v163, v49, v71 op_sel:[1,0,0] op_sel_hi:[1,0,0]
    v_fma_mix_f32 v68, v178, v50, v68 op_sel:[0,0,0] op_sel_hi:[1,0,0]
    v_fma_mix_f32 v69, v178, v50, v69 op_sel:[1,0,0] op_sel_hi:[1,0,0]
    v_fma_mix_f32 v70, v179, v50, v70 op_sel:[0,0,0] op_sel_hi:[1,0,0]
    v_fma_mix_f32 v71, v179, v50, v71 op_sel:[1,0,0] op_sel_hi:[1,0,0]
    v_fma_mix_f32 v68, v194, v51, v68 op_sel:[0,0,0] op_sel_hi:[1,0,0]
    v_fma_mix_f32 v69, v194, v51, v69 op_sel:[1,0,0] op_sel_hi:[1,0,0]
    v_fma_mix_f32 v70, v195, v51, v70 op_sel:[0,0,0] op_sel_hi:[1,0,0]
    v_fma_mix_f32 v71, v195, v51, v71 op_sel:[1,0,0] op_sel_hi:[1,0,0]
    v_cvt_pk_bf16_f32 v98, v68, v69
    v_cvt_pk_bf16_f32 v99, v70, v71
    buffer_store_dwordx2 v[98:99], v22, s[48:51], s80 offen offset:16
    v_fma_mix_f32 v72, v148, v48, 0 op_sel:[0,0,0] op_sel_hi:[1,0,0]
    v_fma_mix_f32 v73, v148, v48, 0 op_sel:[1,0,0] op_sel_hi:[1,0,0]
    v_fma_mix_f32 v74, v149, v48, 0 op_sel:[0,0,0] op_sel_hi:[1,0,0]
    v_fma_mix_f32 v75, v149, v48, 0 op_sel:[1,0,0] op_sel_hi:[1,0,0]
    v_fma_mix_f32 v72, v164, v49, v72 op_sel:[0,0,0] op_sel_hi:[1,0,0]
    v_fma_mix_f32 v73, v164, v49, v73 op_sel:[1,0,0] op_sel_hi:[1,0,0]
    v_fma_mix_f32 v74, v165, v49, v74 op_sel:[0,0,0] op_sel_hi:[1,0,0]
    v_fma_mix_f32 v75, v165, v49, v75 op_sel:[1,0,0] op_sel_hi:[1,0,0]
    v_fma_mix_f32 v72, v180, v50, v72 op_sel:[0,0,0] op_sel_hi:[1,0,0]
    v_fma_mix_f32 v73, v180, v50, v73 op_sel:[1,0,0] op_sel_hi:[1,0,0]
    v_fma_mix_f32 v74, v181, v50, v74 op_sel:[0,0,0] op_sel_hi:[1,0,0]
    v_fma_mix_f32 v75, v181, v50, v75 op_sel:[1,0,0] op_sel_hi:[1,0,0]
    v_fma_mix_f32 v72, v196, v51, v72 op_sel:[0,0,0] op_sel_hi:[1,0,0]
    v_fma_mix_f32 v73, v196, v51, v73 op_sel:[1,0,0] op_sel_hi:[1,0,0]
    v_fma_mix_f32 v74, v197, v51, v74 op_sel:[0,0,0] op_sel_hi:[1,0,0]
    v_fma_mix_f32 v75, v197, v51, v75 op_sel:[1,0,0] op_sel_hi:[1,0,0]
    v_cvt_pk_bf16_f32 v100, v72, v73
    v_cvt_pk_bf16_f32 v101, v74, v75
    buffer_store_dwordx2 v[100:101], v22, s[48:51], s80 offen offset:32
    v_fma_mix_f32 v76, v150, v48, 0 op_sel:[0,0,0] op_sel_hi:[1,0,0]
    v_fma_mix_f32 v77, v150, v48, 0 op_sel:[1,0,0] op_sel_hi:[1,0,0]
    v_fma_mix_f32 v78, v151, v48, 0 op_sel:[0,0,0] op_sel_hi:[1,0,0]
    v_fma_mix_f32 v79, v151, v48, 0 op_sel:[1,0,0] op_sel_hi:[1,0,0]
    v_fma_mix_f32 v76, v166, v49, v76 op_sel:[0,0,0] op_sel_hi:[1,0,0]
    v_fma_mix_f32 v77, v166, v49, v77 op_sel:[1,0,0] op_sel_hi:[1,0,0]
    v_fma_mix_f32 v78, v167, v49, v78 op_sel:[0,0,0] op_sel_hi:[1,0,0]
    v_fma_mix_f32 v79, v167, v49, v79 op_sel:[1,0,0] op_sel_hi:[1,0,0]
    v_fma_mix_f32 v76, v182, v50, v76 op_sel:[0,0,0] op_sel_hi:[1,0,0]
    v_fma_mix_f32 v77, v182, v50, v77 op_sel:[1,0,0] op_sel_hi:[1,0,0]
    v_fma_mix_f32 v78, v183, v50, v78 op_sel:[0,0,0] op_sel_hi:[1,0,0]
    v_fma_mix_f32 v79, v183, v50, v79 op_sel:[1,0,0] op_sel_hi:[1,0,0]
    v_fma_mix_f32 v76, v198, v51, v76 op_sel:[0,0,0] op_sel_hi:[1,0,0]
    v_fma_mix_f32 v77, v198, v51, v77 op_sel:[1,0,0] op_sel_hi:[1,0,0]
    v_fma_mix_f32 v78, v199, v51, v78 op_sel:[0,0,0] op_sel_hi:[1,0,0]
    v_fma_mix_f32 v79, v199, v51, v79 op_sel:[1,0,0] op_sel_hi:[1,0,0]
    v_cvt_pk_bf16_f32 v102, v76, v77
    v_cvt_pk_bf16_f32 v103, v78, v79
    buffer_store_dwordx2 v[102:103], v22, s[48:51], s80 offen offset:48
    v_fma_mix_f32 v80, v152, v48, 0 op_sel:[0,0,0] op_sel_hi:[1,0,0]
    v_fma_mix_f32 v81, v152, v48, 0 op_sel:[1,0,0] op_sel_hi:[1,0,0]
    v_fma_mix_f32 v82, v153, v48, 0 op_sel:[0,0,0] op_sel_hi:[1,0,0]
    v_fma_mix_f32 v83, v153, v48, 0 op_sel:[1,0,0] op_sel_hi:[1,0,0]
    v_fma_mix_f32 v80, v168, v49, v80 op_sel:[0,0,0] op_sel_hi:[1,0,0]
    v_fma_mix_f32 v81, v168, v49, v81 op_sel:[1,0,0] op_sel_hi:[1,0,0]
    v_fma_mix_f32 v82, v169, v49, v82 op_sel:[0,0,0] op_sel_hi:[1,0,0]
    v_fma_mix_f32 v83, v169, v49, v83 op_sel:[1,0,0] op_sel_hi:[1,0,0]
    v_fma_mix_f32 v80, v184, v50, v80 op_sel:[0,0,0] op_sel_hi:[1,0,0]
    v_fma_mix_f32 v81, v184, v50, v81 op_sel:[1,0,0] op_sel_hi:[1,0,0]
    v_fma_mix_f32 v82, v185, v50, v82 op_sel:[0,0,0] op_sel_hi:[1,0,0]
    v_fma_mix_f32 v83, v185, v50, v83 op_sel:[1,0,0] op_sel_hi:[1,0,0]
    v_fma_mix_f32 v80, v200, v51, v80 op_sel:[0,0,0] op_sel_hi:[1,0,0]
    v_fma_mix_f32 v81, v200, v51, v81 op_sel:[1,0,0] op_sel_hi:[1,0,0]
    v_fma_mix_f32 v82, v201, v51, v82 op_sel:[0,0,0] op_sel_hi:[1,0,0]
    v_fma_mix_f32 v83, v201, v51, v83 op_sel:[1,0,0] op_sel_hi:[1,0,0]
    v_cvt_pk_bf16_f32 v104, v80, v81
    v_cvt_pk_bf16_f32 v105, v82, v83
    buffer_store_dwordx2 v[104:105], v22, s[48:51], s80 offen offset:64
    v_fma_mix_f32 v84, v154, v48, 0 op_sel:[0,0,0] op_sel_hi:[1,0,0]
    v_fma_mix_f32 v85, v154, v48, 0 op_sel:[1,0,0] op_sel_hi:[1,0,0]
    v_fma_mix_f32 v86, v155, v48, 0 op_sel:[0,0,0] op_sel_hi:[1,0,0]
    v_fma_mix_f32 v87, v155, v48, 0 op_sel:[1,0,0] op_sel_hi:[1,0,0]
    v_fma_mix_f32 v84, v170, v49, v84 op_sel:[0,0,0] op_sel_hi:[1,0,0]
    v_fma_mix_f32 v85, v170, v49, v85 op_sel:[1,0,0] op_sel_hi:[1,0,0]
    v_fma_mix_f32 v86, v171, v49, v86 op_sel:[0,0,0] op_sel_hi:[1,0,0]
    v_fma_mix_f32 v87, v171, v49, v87 op_sel:[1,0,0] op_sel_hi:[1,0,0]
    v_fma_mix_f32 v84, v186, v50, v84 op_sel:[0,0,0] op_sel_hi:[1,0,0]
    v_fma_mix_f32 v85, v186, v50, v85 op_sel:[1,0,0] op_sel_hi:[1,0,0]
    v_fma_mix_f32 v86, v187, v50, v86 op_sel:[0,0,0] op_sel_hi:[1,0,0]
    v_fma_mix_f32 v87, v187, v50, v87 op_sel:[1,0,0] op_sel_hi:[1,0,0]
    v_fma_mix_f32 v84, v202, v51, v84 op_sel:[0,0,0] op_sel_hi:[1,0,0]
    v_fma_mix_f32 v85, v202, v51, v85 op_sel:[1,0,0] op_sel_hi:[1,0,0]
    v_fma_mix_f32 v86, v203, v51, v86 op_sel:[0,0,0] op_sel_hi:[1,0,0]
    v_fma_mix_f32 v87, v203, v51, v87 op_sel:[1,0,0] op_sel_hi:[1,0,0]
    v_cvt_pk_bf16_f32 v106, v84, v85
    v_cvt_pk_bf16_f32 v107, v86, v87
    buffer_store_dwordx2 v[106:107], v22, s[48:51], s80 offen offset:80
    v_fma_mix_f32 v88, v156, v48, 0 op_sel:[0,0,0] op_sel_hi:[1,0,0]
    v_fma_mix_f32 v89, v156, v48, 0 op_sel:[1,0,0] op_sel_hi:[1,0,0]
    v_fma_mix_f32 v90, v157, v48, 0 op_sel:[0,0,0] op_sel_hi:[1,0,0]
    v_fma_mix_f32 v91, v157, v48, 0 op_sel:[1,0,0] op_sel_hi:[1,0,0]
    v_fma_mix_f32 v88, v172, v49, v88 op_sel:[0,0,0] op_sel_hi:[1,0,0]
    v_fma_mix_f32 v89, v172, v49, v89 op_sel:[1,0,0] op_sel_hi:[1,0,0]
    v_fma_mix_f32 v90, v173, v49, v90 op_sel:[0,0,0] op_sel_hi:[1,0,0]
    v_fma_mix_f32 v91, v173, v49, v91 op_sel:[1,0,0] op_sel_hi:[1,0,0]
    v_fma_mix_f32 v88, v188, v50, v88 op_sel:[0,0,0] op_sel_hi:[1,0,0]
    v_fma_mix_f32 v89, v188, v50, v89 op_sel:[1,0,0] op_sel_hi:[1,0,0]
    v_fma_mix_f32 v90, v189, v50, v90 op_sel:[0,0,0] op_sel_hi:[1,0,0]
    v_fma_mix_f32 v91, v189, v50, v91 op_sel:[1,0,0] op_sel_hi:[1,0,0]
    v_fma_mix_f32 v88, v204, v51, v88 op_sel:[0,0,0] op_sel_hi:[1,0,0]
    v_fma_mix_f32 v89, v204, v51, v89 op_sel:[1,0,0] op_sel_hi:[1,0,0]
    v_fma_mix_f32 v90, v205, v51, v90 op_sel:[0,0,0] op_sel_hi:[1,0,0]
    v_fma_mix_f32 v91, v205, v51, v91 op_sel:[1,0,0] op_sel_hi:[1,0,0]
    v_cvt_pk_bf16_f32 v108, v88, v89
    v_cvt_pk_bf16_f32 v109, v90, v91
    buffer_store_dwordx2 v[108:109], v22, s[48:51], s80 offen offset:96
    v_fma_mix_f32 v92, v158, v48, 0 op_sel:[0,0,0] op_sel_hi:[1,0,0]
    v_fma_mix_f32 v93, v158, v48, 0 op_sel:[1,0,0] op_sel_hi:[1,0,0]
    v_fma_mix_f32 v94, v159, v48, 0 op_sel:[0,0,0] op_sel_hi:[1,0,0]
    v_fma_mix_f32 v95, v159, v48, 0 op_sel:[1,0,0] op_sel_hi:[1,0,0]
    v_fma_mix_f32 v92, v174, v49, v92 op_sel:[0,0,0] op_sel_hi:[1,0,0]
    v_fma_mix_f32 v93, v174, v49, v93 op_sel:[1,0,0] op_sel_hi:[1,0,0]
    v_fma_mix_f32 v94, v175, v49, v94 op_sel:[0,0,0] op_sel_hi:[1,0,0]
    v_fma_mix_f32 v95, v175, v49, v95 op_sel:[1,0,0] op_sel_hi:[1,0,0]
    v_fma_mix_f32 v92, v190, v50, v92 op_sel:[0,0,0] op_sel_hi:[1,0,0]
    v_fma_mix_f32 v93, v190, v50, v93 op_sel:[1,0,0] op_sel_hi:[1,0,0]
    v_fma_mix_f32 v94, v191, v50, v94 op_sel:[0,0,0] op_sel_hi:[1,0,0]
    v_fma_mix_f32 v95, v191, v50, v95 op_sel:[1,0,0] op_sel_hi:[1,0,0]
    v_fma_mix_f32 v92, v206, v51, v92 op_sel:[0,0,0] op_sel_hi:[1,0,0]
    v_fma_mix_f32 v93, v206, v51, v93 op_sel:[1,0,0] op_sel_hi:[1,0,0]
    v_fma_mix_f32 v94, v207, v51, v94 op_sel:[0,0,0] op_sel_hi:[1,0,0]
    v_fma_mix_f32 v95, v207, v51, v95 op_sel:[1,0,0] op_sel_hi:[1,0,0]
    v_cvt_pk_bf16_f32 v110, v92, v93
    v_cvt_pk_bf16_f32 v111, v94, v95
    buffer_store_dwordx2 v[110:111], v22, s[48:51], s80 offen offset:112
    s_mov_b64 exec, 1
    buffer_store_dword v13, v13, s[52:55], s69 offen sc1
    s_mov_b64 exec, -1
L_end:
    s_endpgm
L_hook:
    s_cmp_lg_u32 s62, 120
    s_cbranch_scc1 L_hook2
    s_cmp_ge_u32 s100, 34
    s_cbranch_scc1 L_go_52
L_poll_51:
    ds_read_b32 v39, v14 offset:8
    s_waitcnt lgkmcnt(0)
    v_readfirstlane_b32 s100, v39
    s_nop 0
    s_cmp_ge_u32 s100, 34
    s_cbranch_scc1 L_go_52
    s_sleep 2
    s_sub_u32 s71, s71, 1
    s_cbranch_scc1 L_end
    s_branch L_poll_51
L_go_52:
    s_cmp_ge_u32 s101, 34
    s_cbranch_scc1 L_go_54
L_poll_53:
    ds_read_b32 v39, v14 offset:12
    s_waitcnt lgkmcnt(0)
    v_readfirstlane_b32 s101, v39
    s_nop 0
    s_cmp_ge_u32 s101, 34
    s_cbranch_scc1 L_go_54
    s_sleep 2
    s_sub_u32 s71, s71, 1
    s_cbranch_scc1 L_end
    s_branch L_poll_53
L_go_54:
    v_and_b32 v2, 31, v1
    v_lshlrev_b32 v2, 3, v2
    v_add_u32 v2, 162368, v2
    ds_read_b64 v[48:49], v2
    ds_read_b64 v[50:51], v2 offset:256
    s_waitcnt lgkmcnt(0)
    v_max_f32 v10, v48, v50
    v_sub_f32 v26, v48, v10
    v_sub_f32 v36, v50, v10
    v_exp_f32 v26, v26
    v_exp_f32 v36, v36
    s_nop 0
    v_mul_f32 v49, v49, v26
    v_mul_f32 v51, v51, v36
    v_add_f32 v11, v49, v51
    s_branch L_hook_done
L_hook2:
    s_cmp_lg_u32 s62, 124
    s_cbranch_scc1 L_hook3
    v_mov_b32 v38, 1
    s_mov_b64 exec, 1
    buffer_atomic_add v38, v13, s[52:55], s69 offen sc0
    s_mov_b64 exec, -1
    s_branch L_hook_done
L_hook3:
    s_cmp_lg_u32 s62, 126
    s_cbranch_scc1 L_hook_done
    s_waitcnt vmcnt(0)
    v_readfirstlane_b32 s82, v38
    s_nop 0
    s_and_b32 s72, s82, 0xff
    s_cmp_lt_u32 s72, 3
    s_cbranch_scc1 L_hook_done
    s_waitcnt vmcnt(0)
    v_readfirstlane_b32 s82, v38
    s_nop 0
    s_andn2_b32 s77, s82, s83
    s_and_b32 s77, s77, 256
    s_cbranch_scc0 L_nold_55
    s_or_b32 s83, s83, 256
    s_lshl_b32 s75, s66, 10
    s_add_u32 s75, s75, s60
    s_add_u32 s75, s75, 131072
    buffer_load_dwordx4 v[208:211], v21, s[52:55], s75 offen sc1
    s_lshl_b32 s73, s66, 12
    s_add_u32 s73, s73, s60
    s_add_u32 s73, s73, 0
    buffer_load_dwordx4 v[144:147], v21, s[52:55], s73 offen offset:0 sc1
    buffer_load_dwordx4 v[148:151], v21, s[52:55], s73 offen offset:1024 sc1
    buffer_load_dwordx4 v[152:155], v21, s[52:55], s73 offen offset:2048 sc1
    buffer_load_dwordx4 v[156:159], v21, s[52:55], s73 offen offset:3072 sc1
L_nold_55:
    s_andn2_b32 s77, s82, s83
    s_and_b32 s77, s77, 512
    s_cbranch_scc0 L_nold_56
    s_or_b32 s83, s83, 512
    s_lshl_b32 s75, s66, 10
    s_add_u32 s75, s75, s60
    s_add_u32 s75, s75, 135168
    buffer_load_dwordx4 v[212:215], v21, s[52:55], s75 offen sc1
    s_lshl_b32 s73, s66, 12
    s_add_u32 s73, s73, s60
    s_add_u32 s73, s73, 16384
    buffer_load_dwordx4 v[160:163], v21, s[52:55], s73 offen offset:0 sc1
    buffer_load_dwordx4 v[164:167], v21, s[52:55], s73 offen offset:1024 sc1
    buffer_load_dwordx4 v[168:171], v21, s[52:55], s73 offen offset:2048 sc1
    buffer_load_dwordx4 v[172:175], v21, s[52:55], s73 offen offset:3072 sc1
L_nold_56:
    s_andn2_b32 s77, s82, s83
    s_and_b32 s77, s77, 1024
    s_cbranch_scc0 L_nold_57
    s_or_b32 s83, s83, 1024
    s_lshl_b32 s75, s66, 10
    s_add_u32 s75, s75, s60
    s_add_u32 s75, s75, 139264
    buffer_load_dwordx4 v[216:219], v21, s[52:55], s75 offen sc1
    s_lshl_b32 s73, s66, 12
    s_add_u32 s73, s73, s60
    s_add_u32 s73, s73, 32768
    buffer_load_dwordx4 v[176:179], v21, s[52:55], s73 offen offset:0 sc1
    buffer_load_dwordx4 v[180:183], v21, s[52:55], s73 offen offset:1024 sc1
    buffer_load_dwordx4 v[184:187], v21, s[52:55], s73 offen offset:2048 sc1
    buffer_load_dwordx4 v[188:191], v21, s[52:55], s73 offen offset:3072 sc1
L_nold_57:
    s_andn2_b32 s77, s82, s83
    s_and_b32 s77, s77, 2048
    s_cbranch_scc0 L_nold_58
    s_or_b32 s83, s83, 2048
    s_lshl_b32 s75, s66, 10
    s_add_u32 s75, s75, s60
    s_add_u32 s75, s75, 143360
    buffer_load_dwordx4 v[220:223], v21, s[52:55], s75 offen sc1
    s_lshl_b32 s73, s66, 12
    s_add_u32 s73, s73, s60
    s_add_u32 s73, s73, 49152
    buffer_load_dwordx4 v[192:195], v21, s[52:55], s73 offen offset:0 sc1
    buffer_load_dwordx4 v[196:199], v21, s[52:55], s73 offen offset:1024 sc1
    buffer_load_dwordx4 v[200:203], v21, s[52:55], s73 offen offset:2048 sc1
    buffer_load_dwordx4 v[204:207], v21, s[52:55], s73 offen offset:3072 sc1
L_nold_58:
    s_cmp_eq_u32 s83, 0xf00
    s_cbranch_scc1 L_hook_done
    s_mov_b64 exec, 1
    buffer_load_dword v38, v13, s[52:55], s69 offen sc1
    s_mov_b64 exec, -1
    s_branch L_hook_done
L_scale0:
    v_pk_mul_f32 v[64:65], v[64:65], v[26:27] op_sel_hi:[1,0]
    v_pk_mul_f32 v[66:67], v[66:67], v[26:27] op_sel_hi:[1,0]
    v_pk_mul_f32 v[68:69], v[68:69], v[26:27] op_sel_hi:[1,0]
    v_pk_mul_f32 v[70:71], v[70:71], v[26:27] op_sel_hi:[1,0]
    v_pk_mul_f32 v[72:73], v[72:73], v[26:27] op_sel_hi:[1,0]
    v_pk_mul_f32 v[74:75], v[74:75], v[26:27] op_sel_hi:[1,0]
    v_pk_mul_f32 v[76:77], v[76:77], v[26:27] op_sel_hi:[1,0]
    v_pk_mul_f32 v[78:79], v[78:79], v[26:27] op_sel_hi:[1,0]
    v_pk_mul_f32 v[80:81], v[80:81], v[26:27] op_sel_hi:[1,0]
    v_pk_mul_f32 v[82:83], v[82:83], v[26:27] op_sel_hi:[1,0]
    v_pk_mul_f32 v[84:85], v[84:85], v[26:27] op_sel_hi:[1,0]
    v_pk_mul_f32 v[86:87], v[86:87], v[26:27] op_sel_hi:[1,0]
    v_pk_mul_f32 v[88:89], v[88:89], v[26:27] op_sel_hi:[1,0]
    v_pk_mul_f32 v[90:91], v[90:91], v[26:27] op_sel_hi:[1,0]
    v_pk_mul_f32 v[92:93], v[92:93], v[26:27] op_sel_hi:[1,0]
    v_pk_mul_f32 v[94:95], v[94:95], v[26:27] op_sel_hi:[1,0]
    s_and_b32 s72, s82, 0xff
    s_cmp_lt_u32 s72, 3
    s_cbranch_scc1 L_scale0_done
    s_cmp_eq_u32 s83, 0xf00
    s_cbranch_scc1 L_scale0_done
    s_waitcnt vmcnt(0)
    v_readfirstlane_b32 s82, v38
    s_nop 0
    s_andn2_b32 s77, s82, s83
    s_and_b32 s77, s77, 256
    s_cbranch_scc0 L_nold_59
    s_or_b32 s83, s83, 256
    s_lshl_b32 s75, s66, 10
    s_add_u32 s75, s75, s60
    s_add_u32 s75, s75, 131072
    buffer_load_dwordx4 v[208:211], v21, s[52:55], s75 offen sc1
    s_lshl_b32 s73, s66, 12
    s_add_u32 s73, s73, s60
    s_add_u32 s73, s73, 0
    buffer_load_dwordx4 v[144:147], v21, s[52:55], s73 offen offset:0 sc1
    buffer_load_dwordx4 v[148:151], v21, s[52:55], s73 offen offset:1024 sc1
    buffer_load_dwordx4 v[152:155], v21, s[52:55], s73 offen offset:2048 sc1
    buffer_load_dwordx4 v[156:159], v21, s[52:55], s73 offen offset:3072 sc1
L_nold_59:
    s_andn2_b32 s77, s82, s83
    s_and_b32 s77, s77, 512
    s_cbranch_scc0 L_nold_60
    s_or_b32 s83, s83, 512
    s_lshl_b32 s75, s66, 10
    s_add_u32 s75, s75, s60
    s_add_u32 s75, s75, 135168
    buffer_load_dwordx4 v[212:215], v21, s[52:55], s75 offen sc1
    s_lshl_b32 s73, s66, 12
    s_add_u32 s73, s73, s60
    s_add_u32 s73, s73, 16384
    buffer_load_dwordx4 v[160:163], v21, s[52:55], s73 offen offset:0 sc1
    buffer_load_dwordx4 v[164:167], v21, s[52:55], s73 offen offset:1024 sc1
    buffer_load_dwordx4 v[168:171], v21, s[52:55], s73 offen offset:2048 sc1
    buffer_load_dwordx4 v[172:175], v21, s[52:55], s73 offen offset:3072 sc1
L_nold_60:
    s_andn2_b32 s77, s82, s83
    s_and_b32 s77, s77, 1024
    s_cbranch_scc0 L_nold_61
    s_or_b32 s83, s83, 1024
    s_lshl_b32 s75, s66, 10
    s_add_u32 s75, s75, s60
    s_add_u32 s75, s75, 139264
    buffer_load_dwordx4 v[216:219], v21, s[52:55], s75 offen sc1
    s_lshl_b32 s73, s66, 12
    s_add_u32 s73, s73, s60
    s_add_u32 s73, s73, 32768
    buffer_load_dwordx4 v[176:179], v21, s[52:55], s73 offen offset:0 sc1
    buffer_load_dwordx4 v[180:183], v21, s[52:55], s73 offen offset:1024 sc1
    buffer_load_dwordx4 v[184:187], v21, s[52:55], s73 offen offset:2048 sc1
    buffer_load_dwordx4 v[188:191], v21, s[52:55], s73 offen offset:3072 sc1
L_nold_61:
    s_andn2_b32 s77, s82, s83
    s_and_b32 s77, s77, 2048
    s_cbranch_scc0 L_nold_62
    s_or_b32 s83, s83, 2048
    s_lshl_b32 s75, s66, 10
    s_add_u32 s75, s75, s60
    s_add_u32 s75, s75, 143360
    buffer_load_dwordx4 v[220:223], v21, s[52:55], s75 offen sc1
    s_lshl_b32 s73, s66, 12
    s_add_u32 s73, s73, s60
    s_add_u32 s73, s73, 49152
    buffer_load_dwordx4 v[192:195], v21, s[52:55], s73 offen offset:0 sc1
    buffer_load_dwordx4 v[196:199], v21, s[52:55], s73 offen offset:1024 sc1
    buffer_load_dwordx4 v[200:203], v21, s[52:55], s73 offen offset:2048 sc1
    buffer_load_dwordx4 v[204:207], v21, s[52:55], s73 offen offset:3072 sc1
L_nold_62:
    s_cmp_eq_u32 s83, 0xf00
    s_cbranch_scc1 L_scale0_done
    s_mov_b64 exec, 1
    buffer_load_dword v38, v13, s[52:55], s69 offen sc1
    s_mov_b64 exec, -1
    s_branch L_scale0_done
L_check_loop:
    v_mov_b32 v8, 1
    v_mov_b32 v9, 0
    s_mov_b64 exec, 1
    buffer_atomic_cmpswap v[8:9], v13, s[56:59], 0 offen sc0
    s_mov_b64 exec, -1
    s_waitcnt vmcnt(0)
    v_readfirstlane_b32 s72, v8
    s_nop 0
    s_cmp_eq_u32 s72, 3
    s_cbranch_scc1 L_vphase
    s_cmp_lg_u32 s72, 0
    s_cbranch_scc1 L_check_wait
    v_lshlrev_b32 v8, 18, v1
    s_mov_b32 s72, 147456
    buffer_store_dword v13, v8, s[52:55], s72 offen sc1
    s_mov_b32 s72, 147712
    buffer_store_dword v13, v8, s[52:55], s72 offen sc1
    s_mov_b32 s72, 147968
    buffer_store_dword v13, v8, s[52:55], s72 offen sc1
    s_mov_b32 s72, 148224
    buffer_store_dword v13, v8, s[52:55], s72 offen sc1
    s_waitcnt vmcnt(0)
    v_mov_b32 v8, 3
    s_mov_b64 exec, 1
    buffer_atomic_swap v8, v13, s[56:59], 0 offen
    s_mov_b64 exec, -1
    s_branch L_vphase
L_check_wait:
    s_sleep 8
    s_sub_u32 s71, s71, 1
    s_cbranch_scc1 L_end
    s_branch L_check_loop
.section .rodata,"a"
.p2align 6
.amdhsa_kernel standalone__tree_speculative_verify_tree_attention_over_candidate_token_tree__sampling_kernel
  .amdhsa_next_free_vgpr 256
  .amdhsa_next_free_sgpr 102
  .amdhsa_accum_offset 256
  .amdhsa_group_segment_fixed_size 0
  .amdhsa_kernarg_size 72
  .amdhsa_user_sgpr_count 2
  .amdhsa_user_sgpr_kernarg_segment_ptr 1
  .amdhsa_system_sgpr_workgroup_id_x 1
.end_amdhsa_kernel
```
